```python
import torch

def _softmax(x, axis=-1):
    return torch.softmax(x, dim=axis)
def _gelu(x):
    return torch.nn.functional.gelu(x, approximate="tanh")
def _silu(x):
    return torch.nn.functional.silu(x)
def _sigmoid(x):
    return torch.sigmoid(x)
def _layernorm(x, axis=-1, eps=1e-5):
    m = x.mean(dim=axis, keepdim=True)
    v = x.var(dim=axis, keepdim=True, unbiased=False)
    return (x - m) / torch.sqrt(v + eps)
def _scatter_add(tgt, idx, src, axis=0):
    return tgt.clone().index_add_(axis, idx, src)
def _segment_sum(src, seg, n):
    out = torch.zeros((n,) + src.shape[1:], dtype=src.dtype)
    return out.index_add_(0, seg, src)
def _pad(x, pw):
    flat = tuple(v for pair in reversed(pw) for v in pair)
    return torch.nn.functional.pad(x, flat)

kernel_name = 'parallel_sum__sliding_block_cached__glu_gated_swiglu__decode'

def setup_inputs():

    _w = (lambda a: (lambda t: t.to(torch.bfloat16) if t.is_floating_point() else t)(torch.as_tensor(a)))
    def _A_setup():
        B, Sq, D = 2, 1, 576
        Hq, Hkv, Sk, Dh = 32, 16, 32768, 128
        assert Hq % Hkv == 0, (Hq, Hkv)
        return {
            "x": _w((lambda *s: torch.randn(*s, dtype=torch.bfloat16) * 0.05)(B, Sq, D)),
            "k_cache": _w((lambda *s: torch.randn(*s, dtype=torch.bfloat16) * 1.6)(B, Hkv, Sk, Dh)),
            "v_cache": _w((lambda *s: torch.randn(*s, dtype=torch.bfloat16) * 0.8)(B, Hkv, Sk, Dh)),
            "wq": _w((lambda *s: torch.randn(*s, dtype=torch.bfloat16) * 1.6)(D, Hq * Dh) * (D ** -0.5)),
            "wo": _w((lambda *s: torch.randn(*s, dtype=torch.bfloat16) * 0.8)(Hq * Dh, D) * ((Hq * Dh) ** -0.5)),
        }
    _A_in = _A_setup()

    def _B_setup():
        B, S, D, F = 2, 1, 576, 4608
        return {
            "x": _w((lambda *s: torch.randn(*s, dtype=torch.bfloat16) * 0.05)(B, S, D)),
            "w1": _w((lambda *s: torch.randn(*s, dtype=torch.bfloat16) * 0.4)(D, F) * (2.0 / D) ** 0.5),
            "w3": _w((lambda *s: torch.randn(*s, dtype=torch.bfloat16) * 0.4)(D, F) * (2.0 / D) ** 0.5),
            "w2": _w((lambda *s: torch.randn(*s, dtype=torch.bfloat16) * 0.4)(F, D) * (2.0 / F) ** 0.5),
        }
    _B_in = _B_setup()

    return {
        "A_x": _A_in["x"],
        "A_k_cache": _A_in["k_cache"],
        "A_v_cache": _A_in["v_cache"],
        "A_wq": _A_in["wq"],
        "A_wo": _A_in["wo"],
        "B_x": _B_in["x"],
        "B_w1": _B_in["w1"],
        "B_w3": _B_in["w3"],
        "B_w2": _B_in["w2"],
    }

def reference(A_x, A_k_cache, A_v_cache, A_wq, A_wo, B_x, B_w1, B_w3, B_w2):
    def _A_ref(x, k_cache, v_cache, wq, wo):
        B, Sq, D = x.shape
        Hq, Dh = 32, 128
        Hkv, Sk = k_cache.shape[1], k_cache.shape[2]
        W = min(4096, max(256, Sk // 4))
        rep = Hq // Hkv
        q = (lambda x, *d: x.permute(*d))((x @ wq).reshape(B, Sq, Hq, Dh), 0, 2, 1, 3)
        k = (lambda x, n, axis: torch.repeat_interleave(x, n, dim=axis))(k_cache[:, :, Sk - W:, :], rep, axis=1)
        v = (lambda x, n, axis: torch.repeat_interleave(x, n, dim=axis))(v_cache[:, :, Sk - W:, :], rep, axis=1)
        scores = torch.einsum("bhqd,bhkd->bhqk", q, k) * (Dh ** -0.5)
        p = _softmax(scores, axis=-1)
        o = torch.einsum("bhqk,bhkd->bhqd", p, v)
        return (lambda x, *d: x.permute(*d))(o, 0, 2, 1, 3).reshape(B, Sq, Hq * Dh) @ wo

    def _B_ref(x, w1, w3, w2):
        gate = torch.einsum("bsd,df->bsf", x, w1)
        up = torch.einsum("bsd,df->bsf", x, w3)
        h = _silu(gate) * up
        out = torch.einsum("bsf,fd->bsd", h, w2)
        return out

    x = A_x
    xn = _layernorm(x, axis=-1)
    return x + _A_ref(xn, A_k_cache, A_v_cache, A_wq, A_wo) + _B_ref(xn, B_w1, B_w3, B_w2)
```

```asm
; @launch grid=(256,1,1) block=(576,1,1) lds=13952
.amdgcn_target "amdgcn-amd-amdhsa--gfx950"
.text
.globl parallel_sum__sliding_block_cached__glu_gated_swiglu__decode_kernel
.p2align 8
.type parallel_sum__sliding_block_cached__glu_gated_swiglu__decode_kernel,@function
parallel_sum__sliding_block_cached__glu_gated_swiglu__decode_kernel:
s_load_dwordx16 s[76:91], s[0:1], 0
s_load_dwordx8 s[92:99], s[0:1], 64
v_lshrrev_b32 v1, 6, v0
s_cmp_ge_u32 s2, 256
s_cbranch_scc1 L_end
v_readfirstlane_b32 s3, v1
v_and_b32 v0, 63, v0
s_and_b32 s54, s2, 7
s_lshl_b32 s54, s54, 5
s_lshr_b32 s2, s2, 3
s_add_u32 s2, s2, s54
s_lshr_b32 s48, s2, 4
s_and_b32 s49, s2, 15
s_lshr_b32 s50, s49, 3
s_and_b32 s51, s2, 7
v_lshrrev_b32 v9, 4, v0
s_cmp_eq_u32 s3, 8
s_cbranch_scc1 L_service
s_mov_b32 s10, 268435456
s_mov_b32 s11, 0x00020000
s_lshl4_add_u32 s54, s50, s48
s_lshl_b32 s54, s54, 6
s_add_u32 s54, s54, s51
s_lshl_b32 s54, s54, 7
s_add_u32 s54, s54, s3
s_addk_i32 s54, 7168
s_lshl_b32 s56, s54, 10
v_and_b32 v1, 3, v0
v_lshl_add_u32 v1, v1, 4, s56
v_bfe_u32 v10, v0, 2, 2
v_lshl_add_u32 v1, v10, 8, v1
v_lshl_add_u32 v1, v9, 6, v1
s_lshl3_add_u32 s54, s2, s3
s_mul_i32 s58, s54, 0x9E3779B1
s_bfe_u32 s58, s58, 0x40018
s_lshl_b32 s58, s58, 13
s_waitcnt lgkmcnt(0)
s_mov_b64 s[8:9], s[78:79]
s_xor_b32 s54, s58, 0
buffer_load_dwordx4 v[40:43], v1, s[8:11], s54 offen nt
s_getpc_b64 s[42:43]
L_pca:
s_lshl_b32 s44, s2, 2
s_add_u32 s44, s44, L_tab-L_pca
s_load_dword s62, s[42:43], s44
s_xor_b32 s54, s58, 8192
buffer_load_dwordx4 v[44:47], v1, s[8:11], s54 offen nt
v_lshl_add_u32 v2, v0, 4, s56
s_mov_b32 s14, 268435456
s_mov_b32 s15, 0x00020000
s_mov_b64 s[12:13], s[80:81]
s_mov_b32 s22, 4718592
s_mov_b32 s23, 0x00020000
s_mov_b64 s[20:21], s[84:85]
s_mov_b32 s26, 5308416
s_mov_b32 s27, 0x00020000
s_mov_b64 s[24:25], s[92:93]
s_mov_b32 s34, 71303168
s_mov_b32 s35, 0x00020000
s_mov_b64 s[32:33], s[98:99]
s_mov_b32 s63, 0x3fb8aa3b
s_mov_b32 s64, 0
s_movk_i32 s65, 0x3ff
s_mov_b32 s70, 0x00ff00ff
s_mov_b32 s71, 0x00ff00ff
s_sub_u32 s52, s2, 0
s_cmp_ge_u32 s52, 18
s_cselect_b32 s53, 1, 0
v_and_b32 v11, 1, v0
v_lshlrev_b32 v11, 4, v11
v_mov_b32 v5, 0xffff
v_lshlrev_b32 v11, v11, v5
v_bfe_u32 v10, v0, 1, 2
v_cmp_eq_u32 vcc, 0, v10
s_nop 1
v_cndmask_b32 v5, 0, v11, vcc
v_cmp_eq_u32 vcc, 1, v10
s_nop 1
v_cndmask_b32 v6, 0, v11, vcc
v_cmp_eq_u32 vcc, 2, v10
s_nop 1
v_cndmask_b32 v7, 0, v11, vcc
v_cmp_eq_u32 vcc, 3, v10
s_nop 1
v_cndmask_b32 v8, 0, v11, vcc
v_bfe_u32 v11, v0, 3, 1
s_lshl_b32 s55, s3, 3
v_lshl_add_u32 v3, v9, 1, s55
v_mul_u32_u24 v4, 2304, v11
v_lshl_add_u32 v4, v3, 2, v4
v_add_u32 v3, v3, v11
v_and_b32 v10, 7, v0
v_lshlrev_b32 v10, 4, v10
s_mov_b32 s19, 0x00020000
s_waitcnt lgkmcnt(0)
s_bfe_u32 s75, s62, 0x30013
s_lshr_b32 s55, s62, 22
s_mul_i32 s74, s75, s49
s_lshl4_add_u32 s74, s55, s74
s_lshl_b32 s74, s74, 2
s_and_b32 s46, s62, 255
s_cmp_lt_u32 s46, 136
s_cselect_b64 s[16:17], s[88:89], s[90:91]
s_cselect_b32 s55, 64, 136
s_cmp_lt_u32 s46, 64
s_cselect_b64 s[16:17], s[82:83], s[16:17]
s_cselect_b32 s55, 0, s55
s_movk_i32 s47, 9216
s_cselect_b32 s47, 8192, s47
s_mul_i32 s18, s47, 576
s_sub_u32 s59, s46, s55
s_lshl_b32 s59, s59, 7
s_lshl_b32 s60, s47, 6
v_mad_u32_u24 v3, v3, s47, v10
s_bitcmp1_b32 s62, 8
s_cselect_b32 s54, s59, 1073741824
buffer_load_dwordx4 v[132:135], v3, s[16:19], s54 offen nt
s_add_u32 s59, s59, s60
s_bitcmp1_b32 s62, 9
s_cselect_b32 s54, s59, 1073741824
buffer_load_dwordx4 v[136:139], v3, s[16:19], s54 offen nt
s_add_u32 s59, s59, s60
s_bitcmp1_b32 s62, 10
s_cselect_b32 s54, s59, 1073741824
buffer_load_dwordx4 v[140:143], v3, s[16:19], s54 offen nt
s_add_u32 s59, s59, s60
s_waitcnt vmcnt(4)
s_bitcmp1_b32 s62, 11
s_cselect_b32 s54, s59, 1073741824
buffer_load_dwordx4 v[144:147], v3, s[16:19], s54 offen nt
s_add_u32 s59, s59, s60
s_waitcnt vmcnt(4)
s_bitcmp1_b32 s62, 12
s_cselect_b32 s54, s59, 1073741824
buffer_load_dwordx4 v[148:151], v3, s[16:19], s54 offen nt
s_add_u32 s59, s59, s60
s_waitcnt vmcnt(4)
s_barrier
ds_read_b64 v[32:33], v4 offset:9344
ds_read_b64 v[34:35], v4 offset:9600
ds_read_b64 v[36:37], v4 offset:9856
ds_read_b64 v[38:39], v4 offset:10112
s_waitcnt lgkmcnt(3)
v_and_b32 v12, v32, v5
v_and_b32 v13, v32, v6
v_and_b32 v14, v32, v7
v_and_b32 v15, v32, v8
s_nop 1
v_mfma_f32_16x16x32_bf16 v[24:27], v[12:15], v[132:135], 0
v_and_b32 v16, v33, v5
v_and_b32 v17, v33, v6
v_and_b32 v18, v33, v7
v_and_b32 v19, v33, v8
s_nop 1
v_mfma_f32_16x16x32_bf16 v[28:31], v[16:19], v[132:135], 0
ds_read_b64 v[32:33], v4 offset:10368
s_bitcmp1_b32 s62, 13
s_cselect_b32 s54, s59, 1073741824
buffer_load_dwordx4 v[152:155], v3, s[16:19], s54 offen nt
s_add_u32 s59, s59, s60
s_waitcnt vmcnt(4)
s_waitcnt lgkmcnt(3)
v_and_b32 v12, v34, v5
v_and_b32 v13, v34, v6
v_and_b32 v14, v34, v7
v_and_b32 v15, v34, v8
s_nop 1
v_mfma_f32_16x16x32_bf16 v[24:27], v[12:15], v[136:139], v[24:27]
v_and_b32 v16, v35, v5
v_and_b32 v17, v35, v6
v_and_b32 v18, v35, v7
v_and_b32 v19, v35, v8
s_nop 1
v_mfma_f32_16x16x32_bf16 v[28:31], v[16:19], v[136:139], v[28:31]
ds_read_b64 v[34:35], v4 offset:10624
s_bitcmp1_b32 s62, 14
s_cselect_b32 s54, s59, 1073741824
buffer_load_dwordx4 v[156:159], v3, s[16:19], s54 offen nt
s_add_u32 s59, s59, s60
s_waitcnt vmcnt(4)
s_waitcnt lgkmcnt(3)
v_and_b32 v12, v36, v5
v_and_b32 v13, v36, v6
v_and_b32 v14, v36, v7
v_and_b32 v15, v36, v8
s_nop 1
v_mfma_f32_16x16x32_bf16 v[24:27], v[12:15], v[140:143], v[24:27]
v_and_b32 v16, v37, v5
v_and_b32 v17, v37, v6
v_and_b32 v18, v37, v7
v_and_b32 v19, v37, v8
s_nop 1
v_mfma_f32_16x16x32_bf16 v[28:31], v[16:19], v[140:143], v[28:31]
ds_read_b64 v[36:37], v4 offset:10880
s_bitcmp1_b32 s62, 15
s_cselect_b32 s54, s59, 1073741824
buffer_load_dwordx4 v[160:163], v3, s[16:19], s54 offen nt
s_add_u32 s59, s59, s60
s_waitcnt vmcnt(4)
s_waitcnt lgkmcnt(3)
v_and_b32 v12, v38, v5
v_and_b32 v13, v38, v6
v_and_b32 v14, v38, v7
v_and_b32 v15, v38, v8
s_nop 1
v_mfma_f32_16x16x32_bf16 v[24:27], v[12:15], v[144:147], v[24:27]
v_and_b32 v16, v39, v5
v_and_b32 v17, v39, v6
v_and_b32 v18, v39, v7
v_and_b32 v19, v39, v8
s_nop 1
v_mfma_f32_16x16x32_bf16 v[28:31], v[16:19], v[144:147], v[28:31]
ds_read_b64 v[38:39], v4 offset:11136
s_bitcmp1_b32 s62, 16
s_cselect_b32 s54, s59, 1073741824
buffer_load_dwordx4 v[164:167], v3, s[16:19], s54 offen nt
s_waitcnt vmcnt(4)
s_waitcnt lgkmcnt(3)
v_and_b32 v12, v32, v5
v_and_b32 v13, v32, v6
v_and_b32 v14, v32, v7
v_and_b32 v15, v32, v8
s_nop 1
v_mfma_f32_16x16x32_bf16 v[24:27], v[12:15], v[148:151], v[24:27]
v_and_b32 v16, v33, v5
v_and_b32 v17, v33, v6
v_and_b32 v18, v33, v7
v_and_b32 v19, v33, v8
s_nop 1
v_mfma_f32_16x16x32_bf16 v[28:31], v[16:19], v[148:151], v[28:31]
ds_read_b64 v[32:33], v4 offset:11392
s_xor_b32 s54, s58, 16384
buffer_load_dwordx4 v[48:51], v1, s[8:11], s54 offen nt
s_waitcnt vmcnt(4)
s_waitcnt lgkmcnt(3)
v_and_b32 v12, v34, v5
v_and_b32 v13, v34, v6
v_and_b32 v14, v34, v7
v_and_b32 v15, v34, v8
s_nop 1
v_mfma_f32_16x16x32_bf16 v[24:27], v[12:15], v[152:155], v[24:27]
v_and_b32 v16, v35, v5
v_and_b32 v17, v35, v6
v_and_b32 v18, v35, v7
v_and_b32 v19, v35, v8
s_nop 1
v_mfma_f32_16x16x32_bf16 v[28:31], v[16:19], v[152:155], v[28:31]
s_xor_b32 s54, s58, 24576
buffer_load_dwordx4 v[52:55], v1, s[8:11], s54 offen nt
s_waitcnt vmcnt(4)
s_waitcnt lgkmcnt(2)
v_and_b32 v12, v36, v5
v_and_b32 v13, v36, v6
v_and_b32 v14, v36, v7
v_and_b32 v15, v36, v8
s_nop 1
v_mfma_f32_16x16x32_bf16 v[24:27], v[12:15], v[156:159], v[24:27]
v_and_b32 v16, v37, v5
v_and_b32 v17, v37, v6
v_and_b32 v18, v37, v7
v_and_b32 v19, v37, v8
s_nop 1
v_mfma_f32_16x16x32_bf16 v[28:31], v[16:19], v[156:159], v[28:31]
s_xor_b32 s54, s58, 32768
buffer_load_dwordx4 v[56:59], v1, s[8:11], s54 offen nt
s_waitcnt vmcnt(4)
s_waitcnt lgkmcnt(1)
v_and_b32 v12, v38, v5
v_and_b32 v13, v38, v6
v_and_b32 v14, v38, v7
v_and_b32 v15, v38, v8
s_nop 1
v_mfma_f32_16x16x32_bf16 v[24:27], v[12:15], v[160:163], v[24:27]
v_and_b32 v16, v39, v5
v_and_b32 v17, v39, v6
v_and_b32 v18, v39, v7
v_and_b32 v19, v39, v8
s_nop 1
v_mfma_f32_16x16x32_bf16 v[28:31], v[16:19], v[160:163], v[28:31]
s_xor_b32 s54, s58, 40960
buffer_load_dwordx4 v[60:63], v1, s[8:11], s54 offen nt
s_waitcnt vmcnt(4)
s_waitcnt lgkmcnt(0)
v_and_b32 v12, v32, v5
v_and_b32 v13, v32, v6
v_and_b32 v14, v32, v7
v_and_b32 v15, v32, v8
s_nop 1
v_mfma_f32_16x16x32_bf16 v[24:27], v[12:15], v[164:167], v[24:27]
v_and_b32 v16, v33, v5
v_and_b32 v17, v33, v6
v_and_b32 v18, v33, v7
v_and_b32 v19, v33, v8
s_nop 1
v_mfma_f32_16x16x32_bf16 v[28:31], v[16:19], v[164:167], v[28:31]
v_and_b32 v10, 7, v0
v_lshl_add_u32 v10, v9, 3, v10
s_lshl_b32 s55, s3, 9
v_lshl_add_u32 v10, v10, 4, s55
v_mov_b32 v11, 0
ds_read_b32 v11, v11 offset:9280
s_nop 1
v_add_f32_dpp v24, v28, v24 row_ror:8 row_mask:0xf bank_mask:0xf
v_add_f32_dpp v25, v29, v25 row_ror:8 row_mask:0xf bank_mask:0xf
v_add_f32_dpp v26, v30, v26 row_ror:8 row_mask:0xf bank_mask:0xf
v_add_f32_dpp v27, v31, v27 row_ror:8 row_mask:0xf bank_mask:0xf
s_mov_b64 exec, s[70:71]
ds_write_b128 v10, v[24:27] offset:0
s_mov_b64 exec, -1
s_waitcnt lgkmcnt(0)
s_barrier
v_readfirstlane_b32 s69, v11
v_bfe_u32 v11, v0, 3, 1
v_lshl_add_u32 v3, v9, 2, v11
s_lshl_b32 s55, s2, 4
v_add_u32 v3, s55, v3
v_mul_u32_u24 v3, 1152, v3
v_lshl_add_u32 v4, v9, 1, v11
v_add_u32 v4, s74, v4
v_mul_u32_u24 v4, 1152, v4
v_and_b32 v11, 7, v0
v_lshlrev_b32 v11, 4, v11
s_lshl_b32 s55, s3, 7
v_add_u32 v11, s55, v11
v_add_u32 v3, v3, v11
v_add_u32 v4, v4, v11
s_xor_b32 s54, s58, 49152
buffer_load_dwordx4 v[64:67], v1, s[8:11], s54 offen nt
s_waitcnt vmcnt(4)
s_xor_b32 s54, s58, 57344
buffer_load_dwordx4 v[68:71], v1, s[8:11], s54 offen nt
s_waitcnt vmcnt(4)
s_xor_b32 s54, s58, 65536
buffer_load_dwordx4 v[72:75], v1, s[8:11], s54 offen nt
s_waitcnt vmcnt(4)
s_xor_b32 s54, s58, 73728
buffer_load_dwordx4 v[76:79], v1, s[8:11], s54 offen nt
s_waitcnt vmcnt(4)
s_xor_b32 s54, s58, 81920
buffer_load_dwordx4 v[80:83], v1, s[8:11], s54 offen nt
s_waitcnt vmcnt(4)
s_xor_b32 s54, s58, 90112
buffer_load_dwordx4 v[84:87], v1, s[8:11], s54 offen nt
s_waitcnt vmcnt(4)
s_xor_b32 s54, s58, 98304
buffer_load_dwordx4 v[88:91], v1, s[8:11], s54 offen nt
s_waitcnt vmcnt(4)
s_xor_b32 s54, s58, 106496
buffer_load_dwordx4 v[92:95], v1, s[8:11], s54 offen nt
s_waitcnt vmcnt(4)
s_xor_b32 s54, s58, 114688
buffer_load_dwordx4 v[96:99], v1, s[8:11], s54 offen nt
s_waitcnt vmcnt(4)
s_xor_b32 s54, s58, 122880
buffer_load_dwordx4 v[100:103], v1, s[8:11], s54 offen nt
s_waitcnt vmcnt(4)
s_xor_b32 s54, s58, 0
buffer_load_dwordx4 v[104:107], v2, s[12:15], s54 offen nt
s_waitcnt vmcnt(4)
s_xor_b32 s54, s58, 8192
buffer_load_dwordx4 v[108:111], v2, s[12:15], s54 offen nt
s_waitcnt vmcnt(4)
s_xor_b32 s54, s58, 16384
buffer_load_dwordx4 v[112:115], v2, s[12:15], s54 offen nt
s_waitcnt vmcnt(4)
s_xor_b32 s54, s58, 24576
buffer_load_dwordx4 v[116:119], v2, s[12:15], s54 offen nt
s_waitcnt vmcnt(4)
s_xor_b32 s54, s58, 32768
buffer_load_dwordx4 v[120:123], v2, s[12:15], s54 offen nt
s_waitcnt vmcnt(4)
s_xor_b32 s54, s58, 40960
buffer_load_dwordx4 v[124:127], v2, s[12:15], s54 offen nt
s_waitcnt vmcnt(4)
s_xor_b32 s54, s58, 49152
buffer_load_dwordx4 v[128:131], v2, s[12:15], s54 offen nt
s_waitcnt vmcnt(4)
s_xor_b32 s54, s58, 57344
buffer_load_dwordx4 v[132:135], v2, s[12:15], s54 offen nt
s_waitcnt vmcnt(4)
s_xor_b32 s54, s58, 65536
buffer_load_dwordx4 v[136:139], v2, s[12:15], s54 offen nt
s_waitcnt vmcnt(4)
s_xor_b32 s54, s58, 73728
buffer_load_dwordx4 v[140:143], v2, s[12:15], s54 offen nt
s_waitcnt vmcnt(4)
s_xor_b32 s54, s58, 81920
buffer_load_dwordx4 v[144:147], v2, s[12:15], s54 offen nt
s_waitcnt vmcnt(4)
s_xor_b32 s54, s58, 90112
buffer_load_dwordx4 v[148:151], v2, s[12:15], s54 offen nt
s_waitcnt vmcnt(4)
v_bfe_u32 v11, v0, 1, 1
v_lshlrev_b32 v11, 8, v11
v_lshl_add_u32 v11, v9, 6, v11
v_bfe_u32 v10, v0, 2, 2
v_lshl_add_u32 v11, v10, 4, v11
v_mov_b32 v10, 0
s_branch L_qwait1
L_qwait:
s_sleep 2
L_qwait1:
ds_read_b32 v32, v10 offset:9284
ds_read_b128 v[36:39], v11 offset:8192
s_add_u32 s64, s64, 1
s_cmp_gt_u32 s64, 1600000
s_waitcnt lgkmcnt(0)
v_cmp_eq_u32 vcc, 0, v32
s_cbranch_scc1 L_qgot
s_cbranch_vccnz L_qwait
L_qgot:
v_mfma_f32_16x16x32_bf16 v[12:15], v[40:43], v[36:39], 0
v_mfma_f32_16x16x32_bf16 v[16:19], v[44:47], v[36:39], 0
v_mfma_f32_16x16x32_bf16 v[24:27], v[48:51], v[36:39], 0
v_mfma_f32_16x16x32_bf16 v[28:31], v[52:55], v[36:39], 0
s_nop 4
v_add_f32_dpp v32, v13, v12 row_ror:12 row_mask:0xf bank_mask:0x1
v_add_f32_dpp v32, v14, v32 row_ror:8 row_mask:0xf bank_mask:0x1
v_add_f32_dpp v32, v15, v32 row_ror:4 row_mask:0xf bank_mask:0x1
v_mfma_f32_16x16x32_bf16 v[12:15], v[56:59], v[36:39], 0
v_add_f32_dpp v32, v18, v17 row_ror:12 row_mask:0xf bank_mask:0x2
v_add_f32_dpp v32, v19, v32 row_ror:8 row_mask:0xf bank_mask:0x2
v_add_f32_dpp v32, v16, v32 row_ror:4 row_mask:0xf bank_mask:0x2
v_mfma_f32_16x16x32_bf16 v[16:19], v[60:63], v[36:39], 0
v_add_f32_dpp v32, v27, v26 row_ror:12 row_mask:0xf bank_mask:0x4
v_add_f32_dpp v32, v24, v32 row_ror:8 row_mask:0xf bank_mask:0x4
v_add_f32_dpp v32, v25, v32 row_ror:4 row_mask:0xf bank_mask:0x4
v_mfma_f32_16x16x32_bf16 v[24:27], v[64:67], v[36:39], 0
v_add_f32_dpp v32, v28, v31 row_ror:12 row_mask:0xf bank_mask:0x8
v_add_f32_dpp v32, v29, v32 row_ror:8 row_mask:0xf bank_mask:0x8
v_add_f32_dpp v32, v30, v32 row_ror:4 row_mask:0xf bank_mask:0x8
v_mfma_f32_16x16x32_bf16 v[28:31], v[68:71], v[36:39], 0
v_add_f32_dpp v33, v13, v12 row_ror:12 row_mask:0xf bank_mask:0x1
v_add_f32_dpp v33, v14, v33 row_ror:8 row_mask:0xf bank_mask:0x1
v_add_f32_dpp v33, v15, v33 row_ror:4 row_mask:0xf bank_mask:0x1
v_mfma_f32_16x16x32_bf16 v[12:15], v[72:75], v[36:39], 0
v_add_f32_dpp v33, v18, v17 row_ror:12 row_mask:0xf bank_mask:0x2
v_add_f32_dpp v33, v19, v33 row_ror:8 row_mask:0xf bank_mask:0x2
v_add_f32_dpp v33, v16, v33 row_ror:4 row_mask:0xf bank_mask:0x2
v_mfma_f32_16x16x32_bf16 v[16:19], v[76:79], v[36:39], 0
v_add_f32_dpp v33, v27, v26 row_ror:12 row_mask:0xf bank_mask:0x4
v_add_f32_dpp v33, v24, v33 row_ror:8 row_mask:0xf bank_mask:0x4
v_add_f32_dpp v33, v25, v33 row_ror:4 row_mask:0xf bank_mask:0x4
v_mfma_f32_16x16x32_bf16 v[24:27], v[80:83], v[36:39], 0
v_add_f32_dpp v33, v28, v31 row_ror:12 row_mask:0xf bank_mask:0x8
v_add_f32_dpp v33, v29, v33 row_ror:8 row_mask:0xf bank_mask:0x8
v_add_f32_dpp v33, v30, v33 row_ror:4 row_mask:0xf bank_mask:0x8
v_mfma_f32_16x16x32_bf16 v[28:31], v[84:87], v[36:39], 0
v_add_f32_dpp v34, v13, v12 row_ror:12 row_mask:0xf bank_mask:0x1
v_add_f32_dpp v34, v14, v34 row_ror:8 row_mask:0xf bank_mask:0x1
v_add_f32_dpp v34, v15, v34 row_ror:4 row_mask:0xf bank_mask:0x1
v_mfma_f32_16x16x32_bf16 v[12:15], v[88:91], v[36:39], 0
v_add_f32_dpp v34, v18, v17 row_ror:12 row_mask:0xf bank_mask:0x2
v_add_f32_dpp v34, v19, v34 row_ror:8 row_mask:0xf bank_mask:0x2
v_add_f32_dpp v34, v16, v34 row_ror:4 row_mask:0xf bank_mask:0x2
v_mfma_f32_16x16x32_bf16 v[16:19], v[92:95], v[36:39], 0
v_add_f32_dpp v34, v27, v26 row_ror:12 row_mask:0xf bank_mask:0x4
v_add_f32_dpp v34, v24, v34 row_ror:8 row_mask:0xf bank_mask:0x4
v_add_f32_dpp v34, v25, v34 row_ror:4 row_mask:0xf bank_mask:0x4
v_mfma_f32_16x16x32_bf16 v[24:27], v[96:99], v[36:39], 0
v_add_f32_dpp v34, v28, v31 row_ror:12 row_mask:0xf bank_mask:0x8
v_add_f32_dpp v34, v29, v34 row_ror:8 row_mask:0xf bank_mask:0x8
v_add_f32_dpp v34, v30, v34 row_ror:4 row_mask:0xf bank_mask:0x8
v_mfma_f32_16x16x32_bf16 v[28:31], v[100:103], v[36:39], 0
v_add_f32_dpp v35, v13, v12 row_ror:12 row_mask:0xf bank_mask:0x1
v_add_f32_dpp v35, v14, v35 row_ror:8 row_mask:0xf bank_mask:0x1
v_add_f32_dpp v35, v15, v35 row_ror:4 row_mask:0xf bank_mask:0x1
s_nop 0
v_add_f32_dpp v35, v18, v17 row_ror:12 row_mask:0xf bank_mask:0x2
v_add_f32_dpp v35, v19, v35 row_ror:8 row_mask:0xf bank_mask:0x2
v_add_f32_dpp v35, v16, v35 row_ror:4 row_mask:0xf bank_mask:0x2
s_nop 0
v_add_f32_dpp v35, v27, v26 row_ror:12 row_mask:0xf bank_mask:0x4
v_add_f32_dpp v35, v24, v35 row_ror:8 row_mask:0xf bank_mask:0x4
v_add_f32_dpp v35, v25, v35 row_ror:4 row_mask:0xf bank_mask:0x4
s_nop 0
v_add_f32_dpp v35, v28, v31 row_ror:12 row_mask:0xf bank_mask:0x8
v_add_f32_dpp v35, v29, v35 row_ror:8 row_mask:0xf bank_mask:0x8
v_add_f32_dpp v35, v30, v35 row_ror:4 row_mask:0xf bank_mask:0x8
v_cvt_pk_bf16_f32 v33, v32, v33
v_lshlrev_b32 v32, 16, v33
v_and_b32 v33, 0xffff0000, v33
v_mul_f32 v32, 0x3db504f3, v32
v_mul_f32 v33, 0x3db504f3, v33
v_cvt_pk_bf16_f32 v33, v32, v33
v_lshlrev_b32 v32, 16, v33
v_and_b32 v33, 0xffff0000, v33
v_cvt_pk_bf16_f32 v35, v34, v35
v_lshlrev_b32 v34, 16, v35
v_and_b32 v35, 0xffff0000, v35
v_mul_f32 v34, 0x3db504f3, v34
v_mul_f32 v35, 0x3db504f3, v35
v_cvt_pk_bf16_f32 v35, v34, v35
v_lshlrev_b32 v34, 16, v35
v_and_b32 v35, 0xffff0000, v35
v_max3_f32 v24, v32, v33, v34
v_max_f32 v24, v24, v35
s_nop 1
v_max_f32_dpp v24, v24, v24 row_ror:4 row_mask:0xf bank_mask:0xf
s_nop 1
v_max_f32_dpp v24, v24, v24 row_ror:8 row_mask:0xf bank_mask:0xf
v_mov_b32 v28, v24
s_nop 1
v_permlane16_swap_b32 v24, v28
s_nop 1
v_max_f32 v24, v24, v28
v_mov_b32 v28, v24
s_nop 1
v_permlane32_swap_b32 v24, v28
s_nop 1
v_max_f32 v24, v24, v28
v_mul_f32 v11, s63, v24
v_fma_f32 v32, v32, s63, -v11
v_fma_f32 v33, v33, s63, -v11
v_fma_f32 v34, v34, s63, -v11
v_fma_f32 v35, v35, s63, -v11
v_exp_f32 v32, v32
v_exp_f32 v33, v33
v_exp_f32 v34, v34
v_exp_f32 v35, v35
s_lshl_b32 s55, s3, 3
v_lshl_add_u32 v36, v0, 5, s55
v_add_f32 v25, v32, v33
v_add_f32 v28, v34, v35
v_add_f32 v25, v25, v28
s_nop 1
v_add_f32_dpp v25, v25, v25 row_ror:4 row_mask:0xf bank_mask:0xf
s_nop 1
v_add_f32_dpp v25, v25, v25 row_ror:8 row_mask:0xf bank_mask:0xf
v_mov_b32 v28, v25
s_nop 1
v_permlane16_swap_b32 v25, v28
s_nop 1
v_add_f32 v25, v25, v28
v_mov_b32 v28, v25
s_nop 1
v_permlane32_swap_b32 v25, v28
s_nop 1
v_add_f32 v25, v25, v28
s_mov_b64 exec, 5
ds_write_b64 v36, v[24:25] offset:8960
s_mov_b64 exec, -1
v_mov_b32 v12, 0
v_mov_b32 v13, 0
v_mov_b32 v14, 0
v_mov_b32 v15, 0
v_mov_b32 v16, 0
v_mov_b32 v17, 0
v_mov_b32 v18, 0
v_mov_b32 v19, 0
v_and_b32 v28, 1, v0
v_lshlrev_b32 v28, 4, v28
v_mov_b32 v29, 0xffff
v_lshlrev_b32 v28, v28, v29
v_cvt_pk_bf16_f32 v32, v32, v32
v_cvt_pk_bf16_f32 v33, v33, v33
v_cvt_pk_bf16_f32 v34, v34, v34
v_cvt_pk_bf16_f32 v35, v35, v35
v_and_b32 v32, v32, v28
v_and_b32 v33, v33, v28
v_and_b32 v34, v34, v28
v_and_b32 v35, v35, v28
v_and_b32 v80, 15, v0
v_lshlrev_b32 v80, 5, v80
v_lshl_add_u32 v80, v9, 3, v80
s_lshl_b32 s55, s3, 10
v_add_u32 v80, s55, v80
s_lshl_b32 s55, s75, 1
v_mov_b32 v76, 1073741824
s_sub_i32 s55, s55, 4
v_cmp_gt_i32 vcc, s55, v9
v_add_u32 v94, 9216, v4
s_nop 0
v_cndmask_b32 v94, v76, v94, vcc
s_sub_i32 s55, s55, 4
v_cmp_gt_i32 vcc, s55, v9
v_add_u32 v75, 18432, v4
s_nop 0
v_cndmask_b32 v75, v76, v75, vcc
v_lshrrev_b32 v76, 1, v9
v_mul_u32_u24 v76, 2304, v76
v_and_b32 v77, 7, v0
v_lshl_add_u32 v76, v77, 5, v76
v_and_b32 v77, 1, v9
v_lshl_add_u32 v76, v77, 4, v76
s_mul_i32 s67, s2, 6144
s_lshl_b32 s55, s3, 8
s_add_u32 s67, s67, s55
s_add_u32 s67, s67, 1536
v_bfe_u32 v77, v0, 3, 1
v_lshlrev_b32 v77, 7, v77
v_lshl_add_u32 v77, v9, 3, v77
ds_read_b64 v[68:69], v77 offset:8704
ds_read_b64 v[70:71], v77 offset:8736
ds_read_b64 v[72:73], v77 offset:8768
v_lshrrev_b32 v10, 3, v0
v_lshlrev_b32 v10, 4, v10
s_and_b32 s55, s69, s65
v_mov_b32 v74, s55
s_xor_b32 s54, s58, 98304
buffer_load_dwordx4 v[152:155], v2, s[12:15], s54 offen nt
s_waitcnt vmcnt(4)
v_mov_b32_dpp v12, v32 quad_perm:[0,1,2,3] row_mask:0xf bank_mask:0x1
v_mov_b32_dpp v13, v32 row_ror:4 row_mask:0xf bank_mask:0x2
v_mov_b32_dpp v14, v32 row_ror:8 row_mask:0xf bank_mask:0x4
v_mov_b32_dpp v15, v32 row_ror:12 row_mask:0xf bank_mask:0x8
s_nop 1
v_mfma_f32_16x16x32_bf16 v[20:23], v[12:15], v[104:107], 0
v_mov_b32_dpp v16, v32 row_ror:12 row_mask:0xf bank_mask:0x1
v_mov_b32_dpp v17, v32 quad_perm:[0,1,2,3] row_mask:0xf bank_mask:0x2
v_mov_b32_dpp v18, v32 row_ror:4 row_mask:0xf bank_mask:0x4
v_mov_b32_dpp v19, v32 row_ror:8 row_mask:0xf bank_mask:0x8
s_nop 1
v_mfma_f32_16x16x32_bf16 v[20:23], v[16:19], v[108:111], v[20:23]
v_mov_b32_dpp v12, v32 row_ror:8 row_mask:0xf bank_mask:0x1
v_mov_b32_dpp v13, v32 row_ror:12 row_mask:0xf bank_mask:0x2
v_mov_b32_dpp v14, v32 quad_perm:[0,1,2,3] row_mask:0xf bank_mask:0x4
v_mov_b32_dpp v15, v32 row_ror:4 row_mask:0xf bank_mask:0x8
s_nop 1
v_mfma_f32_16x16x32_bf16 v[20:23], v[12:15], v[112:115], v[20:23]
v_mov_b32_dpp v16, v32 row_ror:4 row_mask:0xf bank_mask:0x1
v_mov_b32_dpp v17, v32 row_ror:8 row_mask:0xf bank_mask:0x2
v_mov_b32_dpp v18, v32 row_ror:12 row_mask:0xf bank_mask:0x4
v_mov_b32_dpp v19, v32 quad_perm:[0,1,2,3] row_mask:0xf bank_mask:0x8
s_nop 1
v_mfma_f32_16x16x32_bf16 v[20:23], v[16:19], v[116:119], v[20:23]
v_mov_b32_dpp v12, v33 quad_perm:[0,1,2,3] row_mask:0xf bank_mask:0x1
v_mov_b32_dpp v13, v33 row_ror:4 row_mask:0xf bank_mask:0x2
v_mov_b32_dpp v14, v33 row_ror:8 row_mask:0xf bank_mask:0x4
v_mov_b32_dpp v15, v33 row_ror:12 row_mask:0xf bank_mask:0x8
s_nop 1
v_mfma_f32_16x16x32_bf16 v[20:23], v[12:15], v[120:123], v[20:23]
v_mov_b32_dpp v16, v33 row_ror:12 row_mask:0xf bank_mask:0x1
v_mov_b32_dpp v17, v33 quad_perm:[0,1,2,3] row_mask:0xf bank_mask:0x2
v_mov_b32_dpp v18, v33 row_ror:4 row_mask:0xf bank_mask:0x4
v_mov_b32_dpp v19, v33 row_ror:8 row_mask:0xf bank_mask:0x8
s_nop 1
v_mfma_f32_16x16x32_bf16 v[20:23], v[16:19], v[124:127], v[20:23]
v_mov_b32_dpp v12, v33 row_ror:8 row_mask:0xf bank_mask:0x1
v_mov_b32_dpp v13, v33 row_ror:12 row_mask:0xf bank_mask:0x2
v_mov_b32_dpp v14, v33 quad_perm:[0,1,2,3] row_mask:0xf bank_mask:0x4
v_mov_b32_dpp v15, v33 row_ror:4 row_mask:0xf bank_mask:0x8
s_nop 1
v_mfma_f32_16x16x32_bf16 v[20:23], v[12:15], v[128:131], v[20:23]
v_mov_b32_dpp v16, v33 row_ror:4 row_mask:0xf bank_mask:0x1
v_mov_b32_dpp v17, v33 row_ror:8 row_mask:0xf bank_mask:0x2
v_mov_b32_dpp v18, v33 row_ror:12 row_mask:0xf bank_mask:0x4
v_mov_b32_dpp v19, v33 quad_perm:[0,1,2,3] row_mask:0xf bank_mask:0x8
s_nop 1
v_mfma_f32_16x16x32_bf16 v[20:23], v[16:19], v[132:135], v[20:23]
v_mov_b32_dpp v12, v34 quad_perm:[0,1,2,3] row_mask:0xf bank_mask:0x1
v_mov_b32_dpp v13, v34 row_ror:4 row_mask:0xf bank_mask:0x2
v_mov_b32_dpp v14, v34 row_ror:8 row_mask:0xf bank_mask:0x4
v_mov_b32_dpp v15, v34 row_ror:12 row_mask:0xf bank_mask:0x8
s_nop 1
v_mfma_f32_16x16x32_bf16 v[20:23], v[12:15], v[136:139], v[20:23]
s_xor_b32 s54, s58, 106496
buffer_load_dwordx4 v[156:159], v2, s[12:15], s54 offen nt
s_waitcnt vmcnt(4)
v_mov_b32_dpp v16, v34 row_ror:12 row_mask:0xf bank_mask:0x1
v_mov_b32_dpp v17, v34 quad_perm:[0,1,2,3] row_mask:0xf bank_mask:0x2
v_mov_b32_dpp v18, v34 row_ror:4 row_mask:0xf bank_mask:0x4
v_mov_b32_dpp v19, v34 row_ror:8 row_mask:0xf bank_mask:0x8
s_nop 1
v_mfma_f32_16x16x32_bf16 v[20:23], v[16:19], v[140:143], v[20:23]
s_xor_b32 s54, s58, 114688
buffer_load_dwordx4 v[160:163], v2, s[12:15], s54 offen nt
s_waitcnt vmcnt(4)
v_mov_b32_dpp v12, v34 row_ror:8 row_mask:0xf bank_mask:0x1
v_mov_b32_dpp v13, v34 row_ror:12 row_mask:0xf bank_mask:0x2
v_mov_b32_dpp v14, v34 quad_perm:[0,1,2,3] row_mask:0xf bank_mask:0x4
v_mov_b32_dpp v15, v34 row_ror:4 row_mask:0xf bank_mask:0x8
s_nop 1
v_mfma_f32_16x16x32_bf16 v[20:23], v[12:15], v[144:147], v[20:23]
s_xor_b32 s54, s58, 122880
buffer_load_dwordx4 v[164:167], v2, s[12:15], s54 offen nt
s_waitcnt vmcnt(4)
v_mov_b32_dpp v16, v34 row_ror:4 row_mask:0xf bank_mask:0x1
v_mov_b32_dpp v17, v34 row_ror:8 row_mask:0xf bank_mask:0x2
v_mov_b32_dpp v18, v34 row_ror:12 row_mask:0xf bank_mask:0x4
v_mov_b32_dpp v19, v34 quad_perm:[0,1,2,3] row_mask:0xf bank_mask:0x8
s_nop 1
v_mfma_f32_16x16x32_bf16 v[20:23], v[16:19], v[148:151], v[20:23]
buffer_load_dwordx4 v[40:43], v4, s[24:27], 0 offen nt
s_waitcnt vmcnt(4)
v_mov_b32_dpp v12, v35 quad_perm:[0,1,2,3] row_mask:0xf bank_mask:0x1
v_mov_b32_dpp v13, v35 row_ror:4 row_mask:0xf bank_mask:0x2
v_mov_b32_dpp v14, v35 row_ror:8 row_mask:0xf bank_mask:0x4
v_mov_b32_dpp v15, v35 row_ror:12 row_mask:0xf bank_mask:0x8
s_nop 1
v_mfma_f32_16x16x32_bf16 v[20:23], v[12:15], v[152:155], v[20:23]
buffer_load_dwordx4 v[44:47], v94, s[24:27], 0 offen nt
s_waitcnt vmcnt(4)
v_mov_b32_dpp v16, v35 row_ror:12 row_mask:0xf bank_mask:0x1
v_mov_b32_dpp v17, v35 quad_perm:[0,1,2,3] row_mask:0xf bank_mask:0x2
v_mov_b32_dpp v18, v35 row_ror:4 row_mask:0xf bank_mask:0x4
v_mov_b32_dpp v19, v35 row_ror:8 row_mask:0xf bank_mask:0x8
s_nop 1
v_mfma_f32_16x16x32_bf16 v[20:23], v[16:19], v[156:159], v[20:23]
s_waitcnt vmcnt(3)
v_mov_b32_dpp v12, v35 row_ror:8 row_mask:0xf bank_mask:0x1
v_mov_b32_dpp v13, v35 row_ror:12 row_mask:0xf bank_mask:0x2
v_mov_b32_dpp v14, v35 quad_perm:[0,1,2,3] row_mask:0xf bank_mask:0x4
v_mov_b32_dpp v15, v35 row_ror:4 row_mask:0xf bank_mask:0x8
s_nop 1
v_mfma_f32_16x16x32_bf16 v[20:23], v[12:15], v[160:163], v[20:23]
s_waitcnt vmcnt(2)
v_mov_b32_dpp v16, v35 row_ror:4 row_mask:0xf bank_mask:0x1
v_mov_b32_dpp v17, v35 row_ror:8 row_mask:0xf bank_mask:0x2
v_mov_b32_dpp v18, v35 row_ror:12 row_mask:0xf bank_mask:0x4
v_mov_b32_dpp v19, v35 quad_perm:[0,1,2,3] row_mask:0xf bank_mask:0x8
s_nop 1
v_mfma_f32_16x16x32_bf16 v[20:23], v[16:19], v[164:167], v[20:23]
s_nop 7
ds_write2st64_b64 v80, v[20:21], v[22:23] offset0:0 offset1:1
s_waitcnt lgkmcnt(0)
s_barrier
s_barrier
buffer_load_dwordx4 v[48:51], v75, s[24:27], 0 offen nt
buffer_load_dwordx4 v[52:55], v3, s[20:23], 0 offen nt
buffer_load_dwordx4 v[56:59], v3, s[20:23], 0 offen offset:2304 nt
s_waitcnt vmcnt(2)
v_and_b32 v12, v68, v5
v_and_b32 v13, v68, v6
v_and_b32 v14, v68, v7
v_and_b32 v15, v68, v8
s_nop 1
v_mfma_f32_16x16x32_bf16 v[24:27], v[12:15], v[40:43], 0
v_and_b32 v16, v69, v5
v_and_b32 v17, v69, v6
v_and_b32 v18, v69, v7
v_and_b32 v19, v69, v8
s_nop 1
v_mfma_f32_16x16x32_bf16 v[28:31], v[16:19], v[40:43], 0
v_and_b32 v12, v70, v5
v_and_b32 v13, v70, v6
v_and_b32 v14, v70, v7
v_and_b32 v15, v70, v8
s_nop 1
v_mfma_f32_16x16x32_bf16 v[24:27], v[12:15], v[44:47], v[24:27]
v_and_b32 v16, v71, v5
v_and_b32 v17, v71, v6
v_and_b32 v18, v71, v7
v_and_b32 v19, v71, v8
s_nop 1
v_mfma_f32_16x16x32_bf16 v[28:31], v[16:19], v[44:47], v[28:31]
v_and_b32 v12, v72, v5
v_and_b32 v13, v72, v6
v_and_b32 v14, v72, v7
v_and_b32 v15, v72, v8
s_nop 1
v_mfma_f32_16x16x32_bf16 v[24:27], v[12:15], v[48:51], v[24:27]
v_and_b32 v16, v73, v5
v_and_b32 v17, v73, v6
v_and_b32 v18, v73, v7
v_and_b32 v19, v73, v8
s_nop 1
v_mfma_f32_16x16x32_bf16 v[28:31], v[16:19], v[48:51], v[28:31]
s_waitcnt vmcnt(0)
s_barrier
ds_read_b128 v[60:63], v10 offset:9088
s_waitcnt lgkmcnt(0)
L_tail:
v_and_b32 v12, v60, v5
v_and_b32 v13, v60, v6
v_and_b32 v14, v60, v7
v_and_b32 v15, v60, v8
s_nop 1
v_mfma_f32_16x16x32_bf16 v[24:27], v[12:15], v[52:55], v[24:27]
v_and_b32 v16, v61, v5
v_and_b32 v17, v61, v6
v_and_b32 v18, v61, v7
v_and_b32 v19, v61, v8
s_nop 1
v_mfma_f32_16x16x32_bf16 v[28:31], v[16:19], v[52:55], v[28:31]
v_and_b32 v12, v62, v5
v_and_b32 v13, v62, v6
v_and_b32 v14, v62, v7
v_and_b32 v15, v62, v8
s_nop 1
v_mfma_f32_16x16x32_bf16 v[24:27], v[12:15], v[56:59], v[24:27]
v_and_b32 v16, v63, v5
v_and_b32 v17, v63, v6
v_and_b32 v18, v63, v7
v_and_b32 v19, v63, v8
s_nop 1
v_mfma_f32_16x16x32_bf16 v[28:31], v[16:19], v[56:59], v[28:31]
s_nop 7
v_add_f32_dpp v24, v28, v24 row_ror:8 row_mask:0xf bank_mask:0xf
v_add_f32_dpp v25, v29, v25 row_ror:8 row_mask:0xf bank_mask:0xf
v_add_f32_dpp v26, v30, v26 row_ror:8 row_mask:0xf bank_mask:0xf
v_add_f32_dpp v27, v31, v27 row_ror:8 row_mask:0xf bank_mask:0xf
v_bfi_b32 v24, s65, v74, v24
v_bfi_b32 v25, s65, v74, v25
v_bfi_b32 v26, s65, v74, v26
v_bfi_b32 v27, s65, v74, v27
s_mov_b64 exec, s[70:71]
buffer_store_dwordx4 v[24:27], v76, s[32:35], s67 offen sc1
s_mov_b64 exec, -1
s_cmp_lg_u32 s3, 8
s_cbranch_scc1 L_nh
s_mov_b64 exec, s[60:61]
buffer_store_dword v74, v118, s[32:35], s59 offen sc1
s_mov_b64 exec, -1
L_nh:
s_cmp_lg_u32 s53, 0
s_cbranch_scc1 L_fin
s_cmp_eq_u32 s3, 8
s_cbranch_scc1 L_final
s_lshl_b32 s54, s3, 5
v_add_u32 v76, s54, v9
v_mul_u32_u24 v76, 6144, v76
v_and_b32 v77, 15, v0
v_lshl_add_u32 v76, v77, 4, v76
s_lshl_b32 s54, s52, 8
s_add_u32 s54, s54, 1536
s_add_u32 s66, s54, 24576
s_add_u32 s67, s54, 49152
s_add_u32 s68, s54, 73728
s_add_u32 s40, s54, 98304
s_add_u32 s41, s54, 122880
s_add_u32 s42, s54, 147456
s_add_u32 s43, s54, 172032
s_add_u32 s57, s64, 100000
v_lshlrev_b32 v78, 2, v9
v_lshl_add_u32 v78, v77, 4, v78
s_lshl_b32 s55, s3, 8
v_add_u32 v78, s55, v78
s_lshl3_add_u32 s55, s52, s3
s_lshl_b32 s55, s55, 7
s_add_u32 s55, s55, 1900544
s_and_b32 s56, s69, s65
L_hint:
s_load_dwordx2 s[60:61], s[32:33], s55 glc
s_add_u32 s64, s64, 1
s_cmp_gt_u32 s64, s57
s_cbranch_scc1 L_hok
s_waitcnt lgkmcnt(0)
s_cmp_lg_u32 s60, s56
s_cbranch_scc1 L_hint
s_cmp_lg_u32 s61, s56
s_cbranch_scc1 L_hint
L_hok:
L_pollf:
buffer_load_dwordx4 v[104:107], v76, s[32:35], s54 offen sc1
buffer_load_dwordx4 v[108:111], v76, s[32:35], s66 offen sc1
buffer_load_dwordx4 v[112:115], v76, s[32:35], s67 offen sc1
buffer_load_dwordx4 v[116:119], v76, s[32:35], s68 offen sc1
buffer_load_dwordx4 v[120:123], v76, s[32:35], s40 offen sc1
buffer_load_dwordx4 v[124:127], v76, s[32:35], s41 offen sc1
buffer_load_dwordx4 v[128:131], v76, s[32:35], s42 offen sc1
buffer_load_dwordx4 v[132:135], v76, s[32:35], s43 offen sc1
s_add_u32 s64, s64, 1
s_cmp_gt_u32 s64, s57
s_waitcnt vmcnt(7)
v_xor_b32 v104, v74, v104
v_xor_b32 v105, v74, v105
v_xor_b32 v106, v74, v106
v_xor_b32 v107, v74, v107
v_or3_b32 v77, v104, v105, v106
v_or_b32 v77, v77, v107
s_waitcnt vmcnt(6)
v_xor_b32 v108, v74, v108
v_xor_b32 v109, v74, v109
v_xor_b32 v110, v74, v110
v_xor_b32 v111, v74, v111
v_or3_b32 v77, v77, v108, v109
v_or3_b32 v77, v77, v110, v111
v_pk_add_f32 v[60:61], v[104:105], v[108:109]
v_pk_add_f32 v[62:63], v[106:107], v[110:111]
s_waitcnt vmcnt(5)
v_xor_b32 v112, v74, v112
v_xor_b32 v113, v74, v113
v_xor_b32 v114, v74, v114
v_xor_b32 v115, v74, v115
v_or3_b32 v77, v77, v112, v113
v_or3_b32 v77, v77, v114, v115
v_pk_add_f32 v[60:61], v[60:61], v[112:113]
v_pk_add_f32 v[62:63], v[62:63], v[114:115]
s_waitcnt vmcnt(4)
v_xor_b32 v116, v74, v116
v_xor_b32 v117, v74, v117
v_xor_b32 v118, v74, v118
v_xor_b32 v119, v74, v119
v_or3_b32 v77, v77, v116, v117
v_or3_b32 v77, v77, v118, v119
v_pk_add_f32 v[60:61], v[60:61], v[116:117]
v_pk_add_f32 v[62:63], v[62:63], v[118:119]
s_waitcnt vmcnt(3)
v_xor_b32 v120, v74, v120
v_xor_b32 v121, v74, v121
v_xor_b32 v122, v74, v122
v_xor_b32 v123, v74, v123
v_or3_b32 v77, v77, v120, v121
v_or3_b32 v77, v77, v122, v123
v_pk_add_f32 v[60:61], v[60:61], v[120:121]
v_pk_add_f32 v[62:63], v[62:63], v[122:123]
s_waitcnt vmcnt(2)
v_xor_b32 v124, v74, v124
v_xor_b32 v125, v74, v125
v_xor_b32 v126, v74, v126
v_xor_b32 v127, v74, v127
v_or3_b32 v77, v77, v124, v125
v_or3_b32 v77, v77, v126, v127
v_pk_add_f32 v[60:61], v[60:61], v[124:125]
v_pk_add_f32 v[62:63], v[62:63], v[126:127]
s_waitcnt vmcnt(1)
v_xor_b32 v128, v74, v128
v_xor_b32 v129, v74, v129
v_xor_b32 v130, v74, v130
v_xor_b32 v131, v74, v131
v_or3_b32 v77, v77, v128, v129
v_or3_b32 v77, v77, v130, v131
v_pk_add_f32 v[60:61], v[60:61], v[128:129]
v_pk_add_f32 v[62:63], v[62:63], v[130:131]
s_waitcnt vmcnt(0)
v_xor_b32 v132, v74, v132
v_xor_b32 v133, v74, v133
v_xor_b32 v134, v74, v134
v_xor_b32 v135, v74, v135
v_or3_b32 v77, v77, v132, v133
v_or3_b32 v77, v77, v134, v135
v_pk_add_f32 v[60:61], v[60:61], v[132:133]
v_pk_add_f32 v[62:63], v[62:63], v[134:135]
v_and_b32 v77, s65, v77
v_cmp_ne_u32 vcc, 0, v77
s_cbranch_scc1 L_gotf
s_cbranch_vccnz L_pollf
L_gotf:
v_permlane16_swap_b32 v60, v61
v_permlane16_swap_b32 v62, v63
s_nop 1
v_add_f32 v60, v60, v61
v_add_f32 v62, v62, v63
s_nop 1
v_permlane32_swap_b32 v60, v62
s_nop 1
v_add_f32 v60, v60, v62
ds_write_b32 v78, v60 offset:0
s_waitcnt lgkmcnt(0)
s_barrier
s_branch L_fin
L_final:
v_lshlrev_b32 v76, 3, v0
v_lshlrev_b32 v78, 16, v125
v_and_b32 v79, 0xffff0000, v125
v_mov_b32 v77, s69
v_mov_b32 v104, 1408
s_cmp_eq_u32 s52, 0
s_cselect_b32 s54, 0, 1073741824
s_mov_b64 exec, 0xffffffff
s_barrier
ds_read_b64 v[80:81], v76 offset:0
ds_read_b64 v[82:83], v76 offset:256
ds_read_b64 v[84:85], v76 offset:512
ds_read_b64 v[86:87], v76 offset:768
ds_read_b64 v[88:89], v76 offset:1024
ds_read_b64 v[90:91], v76 offset:1280
ds_read_b64 v[92:93], v76 offset:1536
ds_read_b64 v[94:95], v76 offset:1792
s_waitcnt lgkmcnt(7)
v_pk_add_f32 v[78:79], v[78:79], v[80:81]
s_waitcnt lgkmcnt(6)
v_pk_add_f32 v[78:79], v[78:79], v[82:83]
s_waitcnt lgkmcnt(5)
v_pk_add_f32 v[78:79], v[78:79], v[84:85]
s_waitcnt lgkmcnt(4)
v_pk_add_f32 v[78:79], v[78:79], v[86:87]
s_waitcnt lgkmcnt(3)
v_pk_add_f32 v[78:79], v[78:79], v[88:89]
s_waitcnt lgkmcnt(2)
v_pk_add_f32 v[78:79], v[78:79], v[90:91]
s_waitcnt lgkmcnt(1)
v_pk_add_f32 v[78:79], v[78:79], v[92:93]
s_waitcnt lgkmcnt(0)
v_pk_add_f32 v[78:79], v[78:79], v[94:95]
v_cvt_pk_bf16_f32 v78, v78, v79
buffer_store_dword v78, v124, s[28:31], 0 offen
s_mov_b64 exec, 1
buffer_store_dword v77, v104, s[32:35], s54 offen sc1
L_fin:
L_end:
s_endpgm
L_service:
s_mov_b32 s6, 2304
s_mov_b32 s7, 0x00020000
s_mov_b32 s34, 71303168
s_mov_b32 s35, 0x00020000
v_lshrrev_b32 v3, 5, v0
v_mul_u32_u24 v4, 1152, v3
v_and_b32 v11, 31, v0
v_mad_u32_u24 v4, v11, 36, v4
s_setprio 3
s_waitcnt lgkmcnt(0)
s_mov_b64 s[4:5], s[76:77]
buffer_load_dwordx4 v[112:115], v4, s[4:7], 0 offen
buffer_load_dwordx4 v[116:119], v4, s[4:7], 0 offen offset:16
buffer_load_dword v120, v4, s[4:7], 0 offen offset:32
s_setprio 0
s_mov_b64 s[32:33], s[98:99]
s_load_dword s69, s[32:33], 1408
s_getpc_b64 s[42:43]
L_pcb:
s_lshl_b32 s44, s2, 2
s_add_u32 s44, s44, L_tab-L_pcb
s_load_dword s62, s[42:43], s44
v_lshlrev_b32 v1, 4, v0
v_mov_b32 v108, 0
v_lshlrev_b32 v109, 2, v0
ds_write_b32 v108, v108 offset:9284
v_mov_b32 v110, -1
v_and_b32 v109, 124, v109
ds_write_b32 v109, v110 offset:8960
s_mov_b32 s22, 4718592
s_mov_b32 s23, 0x00020000
s_mov_b64 s[20:21], s[84:85]
s_mov_b32 s26, 5308416
s_mov_b32 s27, 0x00020000
s_mov_b64 s[24:25], s[92:93]
s_mov_b32 s30, 2304
s_mov_b32 s31, 0x00020000
s_mov_b64 s[28:29], s[94:95]
s_mov_b32 s63, 0x3fb8aa3b
s_mov_b32 s64, 0
s_movk_i32 s65, 0x3ff
s_mov_b32 s70, 0x00ff00ff
s_mov_b32 s71, 0x00ff00ff
s_sub_u32 s52, s2, 0
s_cmp_ge_u32 s52, 18
s_cselect_b32 s53, 1, 0
v_and_b32 v11, 1, v0
v_lshlrev_b32 v11, 4, v11
v_mov_b32 v5, 0xffff
v_lshlrev_b32 v11, v11, v5
v_bfe_u32 v109, v0, 1, 2
v_cmp_eq_u32 vcc, 0, v109
s_nop 1
v_cndmask_b32 v5, 0, v11, vcc
v_cmp_eq_u32 vcc, 1, v109
s_nop 1
v_cndmask_b32 v6, 0, v11, vcc
v_cmp_eq_u32 vcc, 2, v109
s_nop 1
v_cndmask_b32 v7, 0, v11, vcc
v_cmp_eq_u32 vcc, 3, v109
s_nop 1
v_cndmask_b32 v8, 0, v11, vcc
v_lshlrev_b32 v4, 1, v4
s_waitcnt vmcnt(0)
v_lshlrev_b32 v12, 16, v112
v_and_b32 v13, 0xffff0000, v112
v_lshlrev_b32 v14, 16, v113
v_and_b32 v15, 0xffff0000, v113
v_lshlrev_b32 v16, 16, v114
v_and_b32 v17, 0xffff0000, v114
v_lshlrev_b32 v18, 16, v115
v_and_b32 v19, 0xffff0000, v115
v_lshlrev_b32 v20, 16, v116
v_and_b32 v21, 0xffff0000, v116
v_lshlrev_b32 v22, 16, v117
v_and_b32 v23, 0xffff0000, v117
v_lshlrev_b32 v24, 16, v118
v_and_b32 v25, 0xffff0000, v118
v_lshlrev_b32 v26, 16, v119
v_and_b32 v27, 0xffff0000, v119
v_lshlrev_b32 v28, 16, v120
v_and_b32 v29, 0xffff0000, v120
v_add_f32 v112, v12, v13
v_add_f32 v113, v14, v15
v_add_f32 v112, v112, v16
v_add_f32 v113, v113, v17
v_add_f32 v112, v112, v18
v_add_f32 v113, v113, v19
v_add_f32 v112, v112, v20
v_add_f32 v113, v113, v21
v_add_f32 v112, v112, v22
v_add_f32 v113, v113, v23
v_add_f32 v112, v112, v24
v_add_f32 v113, v113, v25
v_add_f32 v112, v112, v26
v_add_f32 v113, v113, v27
v_add_f32 v112, v112, v28
v_add_f32 v113, v113, v29
v_add_f32 v112, v112, v113
s_nop 1
v_add_f32_dpp v112, v112, v112 row_ror:1 row_mask:0xf bank_mask:0xf
s_nop 1
v_add_f32_dpp v112, v112, v112 row_ror:2 row_mask:0xf bank_mask:0xf
s_nop 1
v_add_f32_dpp v112, v112, v112 row_ror:4 row_mask:0xf bank_mask:0xf
s_nop 1
v_add_f32_dpp v112, v112, v112 row_ror:8 row_mask:0xf bank_mask:0xf
v_mov_b32 v113, v112
s_nop 1
v_permlane16_swap_b32 v112, v113
s_nop 1
v_add_f32 v112, v112, v113
v_mul_f32 v112, 0x3ae38e39, v112
v_sub_f32 v40, v12, v112
v_sub_f32 v41, v13, v112
v_sub_f32 v42, v14, v112
v_sub_f32 v43, v15, v112
v_sub_f32 v44, v16, v112
v_sub_f32 v45, v17, v112
v_sub_f32 v46, v18, v112
v_sub_f32 v47, v19, v112
v_sub_f32 v48, v20, v112
v_sub_f32 v49, v21, v112
v_sub_f32 v50, v22, v112
v_sub_f32 v51, v23, v112
v_sub_f32 v52, v24, v112
v_sub_f32 v53, v25, v112
v_sub_f32 v54, v26, v112
v_sub_f32 v55, v27, v112
v_sub_f32 v56, v28, v112
v_sub_f32 v57, v29, v112
v_mul_f32 v114, v40, v40
v_mul_f32 v115, v41, v41
v_fmac_f32 v114, v42, v42
v_fmac_f32 v115, v43, v43
v_fmac_f32 v114, v44, v44
v_fmac_f32 v115, v45, v45
v_fmac_f32 v114, v46, v46
v_fmac_f32 v115, v47, v47
v_fmac_f32 v114, v48, v48
v_fmac_f32 v115, v49, v49
v_fmac_f32 v114, v50, v50
v_fmac_f32 v115, v51, v51
v_fmac_f32 v114, v52, v52
v_fmac_f32 v115, v53, v53
v_fmac_f32 v114, v54, v54
v_fmac_f32 v115, v55, v55
v_fmac_f32 v114, v56, v56
v_fmac_f32 v115, v57, v57
v_add_f32 v114, v114, v115
s_nop 1
v_add_f32_dpp v114, v114, v114 row_ror:1 row_mask:0xf bank_mask:0xf
s_nop 1
v_add_f32_dpp v114, v114, v114 row_ror:2 row_mask:0xf bank_mask:0xf
s_nop 1
v_add_f32_dpp v114, v114, v114 row_ror:4 row_mask:0xf bank_mask:0xf
s_nop 1
v_add_f32_dpp v114, v114, v114 row_ror:8 row_mask:0xf bank_mask:0xf
v_mov_b32 v115, v114
s_nop 1
v_permlane16_swap_b32 v114, v115
s_nop 1
v_add_f32 v114, v114, v115
v_mul_f32 v114, 0x3ae38e39, v114
v_cvt_pk_bf16_f32 v114, v114, v114
v_and_b32 v114, 0xffff0000, v114
v_add_f32 v114, 0x3727c5ac, v114
v_cvt_pk_bf16_f32 v114, v114, v114
v_and_b32 v114, 0xffff0000, v114
v_sqrt_f32 v114, v114
v_cvt_pk_bf16_f32 v112, v112, v112
v_and_b32 v112, 0xffff0000, v112
v_cvt_pk_bf16_f32 v114, v114, v114
v_and_b32 v114, 0xffff0000, v114
v_rcp_f32 v114, v114
v_sub_f32 v12, v12, v112
v_sub_f32 v13, v13, v112
v_sub_f32 v14, v14, v112
v_sub_f32 v15, v15, v112
v_sub_f32 v16, v16, v112
v_sub_f32 v17, v17, v112
v_sub_f32 v18, v18, v112
v_sub_f32 v19, v19, v112
v_sub_f32 v20, v20, v112
v_sub_f32 v21, v21, v112
v_sub_f32 v22, v22, v112
v_sub_f32 v23, v23, v112
v_sub_f32 v24, v24, v112
v_sub_f32 v25, v25, v112
v_sub_f32 v26, v26, v112
v_sub_f32 v27, v27, v112
v_sub_f32 v28, v28, v112
v_sub_f32 v29, v29, v112
v_cvt_pk_bf16_f32 v13, v12, v13
v_lshlrev_b32 v12, 16, v13
v_and_b32 v13, 0xffff0000, v13
v_mul_f32 v12, v12, v114
v_mul_f32 v13, v13, v114
v_cvt_pk_bf16_f32 v12, v12, v12
v_cvt_pk_bf16_f32 v13, v13, v13
ds_write_b64 v4, v[12:13] offset:9344
v_cvt_pk_bf16_f32 v15, v14, v15
v_lshlrev_b32 v14, 16, v15
v_and_b32 v15, 0xffff0000, v15
v_mul_f32 v14, v14, v114
v_mul_f32 v15, v15, v114
v_cvt_pk_bf16_f32 v14, v14, v14
v_cvt_pk_bf16_f32 v15, v15, v15
ds_write_b64 v4, v[14:15] offset:9352
v_cvt_pk_bf16_f32 v17, v16, v17
v_lshlrev_b32 v16, 16, v17
v_and_b32 v17, 0xffff0000, v17
v_mul_f32 v16, v16, v114
v_mul_f32 v17, v17, v114
v_cvt_pk_bf16_f32 v16, v16, v16
v_cvt_pk_bf16_f32 v17, v17, v17
ds_write_b64 v4, v[16:17] offset:9360
v_cvt_pk_bf16_f32 v19, v18, v19
v_lshlrev_b32 v18, 16, v19
v_and_b32 v19, 0xffff0000, v19
v_mul_f32 v18, v18, v114
v_mul_f32 v19, v19, v114
v_cvt_pk_bf16_f32 v18, v18, v18
v_cvt_pk_bf16_f32 v19, v19, v19
ds_write_b64 v4, v[18:19] offset:9368
v_cvt_pk_bf16_f32 v21, v20, v21
v_lshlrev_b32 v20, 16, v21
v_and_b32 v21, 0xffff0000, v21
v_mul_f32 v20, v20, v114
v_mul_f32 v21, v21, v114
v_cvt_pk_bf16_f32 v20, v20, v20
v_cvt_pk_bf16_f32 v21, v21, v21
ds_write_b64 v4, v[20:21] offset:9376
v_cvt_pk_bf16_f32 v23, v22, v23
v_lshlrev_b32 v22, 16, v23
v_and_b32 v23, 0xffff0000, v23
v_mul_f32 v22, v22, v114
v_mul_f32 v23, v23, v114
v_cvt_pk_bf16_f32 v22, v22, v22
v_cvt_pk_bf16_f32 v23, v23, v23
ds_write_b64 v4, v[22:23] offset:9384
v_cvt_pk_bf16_f32 v25, v24, v25
v_lshlrev_b32 v24, 16, v25
v_and_b32 v25, 0xffff0000, v25
v_mul_f32 v24, v24, v114
v_mul_f32 v25, v25, v114
v_cvt_pk_bf16_f32 v24, v24, v24
v_cvt_pk_bf16_f32 v25, v25, v25
ds_write_b64 v4, v[24:25] offset:9392
v_cvt_pk_bf16_f32 v27, v26, v27
v_lshlrev_b32 v26, 16, v27
v_and_b32 v27, 0xffff0000, v27
v_mul_f32 v26, v26, v114
v_mul_f32 v27, v27, v114
v_cvt_pk_bf16_f32 v26, v26, v26
v_cvt_pk_bf16_f32 v27, v27, v27
ds_write_b64 v4, v[26:27] offset:9400
v_cvt_pk_bf16_f32 v29, v28, v29
v_lshlrev_b32 v28, 16, v29
v_and_b32 v29, 0xffff0000, v29
v_mul_f32 v28, v28, v114
v_mul_f32 v29, v29, v114
v_cvt_pk_bf16_f32 v28, v28, v28
v_cvt_pk_bf16_f32 v29, v29, v29
ds_write_b64 v4, v[28:29] offset:9408
s_waitcnt lgkmcnt(0)
s_add_u32 s69, s69, 1
v_mov_b32 v74, s69
ds_write_b32 v108, v74 offset:9280
s_waitcnt lgkmcnt(0)
s_barrier
s_and_b32 s54, s69, s65
v_mov_b32 v74, s54
s_bfe_u32 s40, s69, 0x6000a
s_lshl_b32 s40, s40, 20
s_add_u32 s40, s40, 4194304
s_bfe_u32 s75, s62, 0x30013
s_lshr_b32 s55, s62, 22
s_mul_i32 s74, s75, s49
s_lshl4_add_u32 s74, s55, s74
s_lshl_b32 s74, s74, 2
s_and_b32 s46, s62, 255
v_and_b32 v105, 7, v0
v_bfe_u32 v104, v0, 3, 1
v_bfe_u32 v100, v0, 4, 1
v_mul_u32_u24 v106, 106496, v100
v_mul_u32_u24 v100, 53248, v100
v_lshl_add_u32 v100, v105, 5, v100
v_lshl_add_u32 v100, v104, 4, v100
s_bfe_u32 s54, s62, 0x10011
v_xor_b32 v107, s54, v3
v_mul_u32_u24 v107, 106496, v107
v_add_u32 v100, v100, v107
s_mov_b32 s38, -1
s_bitcmp1_b32 s62, 18
s_cselect_b32 s39, -1, 0
s_lshl_b32 s36, s46, 8
s_add_u32 s36, s36, 1572864
s_cmp_lt_u32 s46, 208
s_cselect_b32 s36, s36, 1073741824
s_mul_i32 s56, s50, 53248
s_lshl_b32 s57, s48, 10
s_add_u32 s56, s56, s57
s_add_u32 s56, s56, 1572864
s_add_u32 s67, s56, 106496
v_mul_u32_u24 v4, 53248, v104
v_mul_u32_u24 v3, 18432, v3
v_add3_u32 v4, v4, v3, v106
v_lshl_add_u32 v4, v105, 4, v4
v_mov_b32 v107, 1073741824
v_cmp_gt_u32 vcc, s75, v105
s_nop 1
v_cndmask_b32 v4, v107, v4, vcc
v_cndmask_b32 v63, 0, v74, vcc
s_lshl_b32 s57, s74, 2
s_add_u32 s57, s57, 1589248
s_mov_b32 s37, 0
s_mov_b32 s66, 0
s_sub_u32 s68, s40, 1572864
v_mov_b32 v96, 0
v_mov_b32 v97, 0
v_mov_b32 v98, 0
v_mov_b32 v99, 0
s_barrier
s_mov_b64 exec, 0xffffffff
ds_read_b128 v[112:115], v1 offset:0
ds_read_b128 v[116:119], v1 offset:512
ds_read_b128 v[120:123], v1 offset:1024
ds_read_b128 v[124:127], v1 offset:1536
ds_read_b128 v[128:131], v1 offset:2048
ds_read_b128 v[132:135], v1 offset:2560
ds_read_b128 v[136:139], v1 offset:3072
ds_read_b128 v[140:143], v1 offset:3584
s_waitcnt lgkmcnt(6)
v_add_f32 v96, v112, v116
v_add_f32 v97, v113, v117
v_add_f32 v98, v114, v118
v_add_f32 v99, v115, v119
s_waitcnt lgkmcnt(5)
v_add_f32 v96, v96, v120
v_add_f32 v97, v97, v121
v_add_f32 v98, v98, v122
v_add_f32 v99, v99, v123
s_waitcnt lgkmcnt(4)
v_add_f32 v96, v96, v124
v_add_f32 v97, v97, v125
v_add_f32 v98, v98, v126
v_add_f32 v99, v99, v127
s_waitcnt lgkmcnt(3)
v_add_f32 v96, v96, v128
v_add_f32 v97, v97, v129
v_add_f32 v98, v98, v130
v_add_f32 v99, v99, v131
s_waitcnt lgkmcnt(2)
v_add_f32 v96, v96, v132
v_add_f32 v97, v97, v133
v_add_f32 v98, v98, v134
v_add_f32 v99, v99, v135
s_waitcnt lgkmcnt(1)
v_add_f32 v96, v96, v136
v_add_f32 v97, v97, v137
v_add_f32 v98, v98, v138
v_add_f32 v99, v99, v139
s_waitcnt lgkmcnt(0)
v_add_f32 v96, v96, v140
v_add_f32 v97, v97, v141
v_add_f32 v98, v98, v142
v_add_f32 v99, v99, v143
s_bitcmp1_b32 s62, 18
s_cbranch_scc1 L_whole
v_add_u32 v96, 512, v96
v_add_u32 v97, 512, v97
v_add_u32 v98, 512, v98
v_add_u32 v99, 512, v99
s_branch L_part
L_whole:
v_cvt_pk_bf16_f32 v96, v96, v96
v_and_b32 v96, 0xffff0000, v96
v_cvt_pk_bf16_f32 v97, v97, v97
v_and_b32 v97, 0xffff0000, v97
v_cvt_pk_bf16_f32 v98, v98, v98
v_and_b32 v98, 0xffff0000, v98
v_cvt_pk_bf16_f32 v99, v99, v99
v_and_b32 v99, 0xffff0000, v99
L_part:
s_mov_b64 exec, -1
v_bfi_b32 v96, s65, v74, v96
v_bfi_b32 v97, s65, v74, v97
v_bfi_b32 v98, s65, v74, v98
v_bfi_b32 v99, s65, v74, v99
s_mov_b64 exec, s[38:39]
s_setprio 3
buffer_store_dwordx4 v[96:99], v100, s[32:35], s36 offen
s_setprio 0
s_mov_b64 exec, -1
L_gather:
s_setprio 3
buffer_load_dwordx4 v[112:115], v1, s[32:35], s56 offen sc1
buffer_load_dwordx4 v[116:119], v1, s[32:35], s67 offen sc1
buffer_load_dwordx4 v[40:43], v4, s[32:35], s57 offen sc1
s_setprio 0
s_add_u32 s64, s64, 1
s_waitcnt vmcnt(0)
v_xor_b32 v112, v74, v112
v_xor_b32 v113, v74, v113
v_xor_b32 v114, v74, v114
v_xor_b32 v115, v74, v115
v_xor_b32 v116, v74, v116
v_xor_b32 v117, v74, v117
v_xor_b32 v118, v74, v118
v_xor_b32 v119, v74, v119
v_xor_b32 v40, v63, v40
v_xor_b32 v41, v63, v41
v_xor_b32 v42, v63, v42
v_xor_b32 v43, v63, v43
v_or3_b32 v104, v112, v113, v114
v_or3_b32 v104, v104, v115, v116
v_or3_b32 v104, v104, v117, v118
v_or3_b32 v104, v104, v119, v40
v_or3_b32 v104, v104, v41, v42
v_or_b32 v104, v104, v43
v_and_b32 v104, s65, v104
v_cmp_ne_u32 vcc, 0, v104
s_cbranch_vccz L_gotg
s_cmp_lt_u32 s64, 12
s_cbranch_scc1 L_gather
s_cmp_lg_u32 s37, 0
s_cbranch_scc1 L_spg
s_add_u32 s36, s36, s40
s_sub_u32 s36, s36, 1572864
s_mov_b32 s37, 1
s_mov_b64 exec, s[38:39]
s_setprio 3
buffer_store_dwordx4 v[96:99], v100, s[32:35], s36 offen sc1
s_setprio 0
s_mov_b64 exec, -1
L_spg:
s_sub_u32 s56, s56, s66
s_sub_u32 s67, s67, s66
s_sub_u32 s57, s57, s66
s_xor_b32 s66, s66, s68
s_add_u32 s56, s56, s66
s_add_u32 s67, s67, s66
s_add_u32 s57, s57, s66
s_cmp_lt_u32 s64, 100000
s_cbranch_scc1 L_gather
L_gotg:
v_add_f32 v112, v112, v116
v_add_f32 v113, v113, v117
v_add_f32 v114, v114, v118
v_add_f32 v115, v115, v119
v_cvt_pk_bf16_f32 v112, v112, v113
v_cvt_pk_bf16_f32 v113, v114, v115
v_lshlrev_b32 v3, 3, v0
ds_write_b64 v3, v[112:113] offset:8192
v_mov_b32 v44, v40
v_mov_b32 v45, v41
v_mov_b32 v46, v42
v_mov_b32 v47, v43
s_nop 1
v_permlane16_swap_b32 v40, v44
v_permlane16_swap_b32 v41, v45
v_permlane16_swap_b32 v42, v46
v_permlane16_swap_b32 v43, v47
s_nop 1
v_add_f32 v40, v40, v44
v_add_f32 v41, v41, v45
v_add_f32 v42, v42, v46
v_add_f32 v43, v43, v47
v_cvt_pk_bf16_f32 v40, v40, v40
v_and_b32 v40, 0xffff0000, v40
v_cvt_pk_bf16_f32 v41, v41, v41
v_and_b32 v41, 0xffff0000, v41
v_cvt_pk_bf16_f32 v42, v42, v42
v_and_b32 v42, 0xffff0000, v42
v_cvt_pk_bf16_f32 v43, v43, v43
v_and_b32 v43, 0xffff0000, v43
v_mov_b32 v44, v40
v_mov_b32 v45, v41
v_mov_b32 v46, v42
v_mov_b32 v47, v43
s_nop 1
v_permlane32_swap_b32 v40, v44
v_permlane32_swap_b32 v41, v45
v_permlane32_swap_b32 v42, v46
v_permlane32_swap_b32 v43, v47
s_nop 1
v_mul_f32 v48, s63, v40
v_mul_f32 v49, s63, v41
v_mul_f32 v50, s63, v42
v_mul_f32 v51, s63, v43
v_exp_f32 v48, -v48
v_exp_f32 v49, -v49
v_exp_f32 v50, -v50
v_exp_f32 v51, -v51
v_add_f32 v48, 1.0, v48
v_add_f32 v49, 1.0, v49
v_add_f32 v50, 1.0, v50
v_add_f32 v51, 1.0, v51
v_rcp_f32 v48, v48
v_rcp_f32 v49, v49
v_rcp_f32 v50, v50
v_rcp_f32 v51, v51
v_mul_f32 v40, v40, v48
v_mul_f32 v41, v41, v49
v_mul_f32 v42, v42, v50
v_mul_f32 v43, v43, v51
v_cvt_pk_bf16_f32 v40, v40, v40
v_and_b32 v40, 0xffff0000, v40
v_cvt_pk_bf16_f32 v41, v41, v41
v_and_b32 v41, 0xffff0000, v41
v_cvt_pk_bf16_f32 v42, v42, v42
v_and_b32 v42, 0xffff0000, v42
v_cvt_pk_bf16_f32 v43, v43, v43
v_and_b32 v43, 0xffff0000, v43
v_mul_f32 v40, v40, v44
v_mul_f32 v41, v41, v45
v_mul_f32 v42, v42, v46
v_mul_f32 v43, v43, v47
v_cvt_pk_bf16_f32 v40, v40, v40
v_cvt_pk_bf16_f32 v41, v41, v41
v_cvt_pk_bf16_f32 v42, v42, v42
v_cvt_pk_bf16_f32 v43, v43, v43
s_mov_b64 exec, 0xffff
ds_write_b128 v1, v[40:43] offset:8704
s_mov_b64 exec, -1
v_mov_b32 v107, 1
s_waitcnt lgkmcnt(0)
ds_write_b32 v108, v107 offset:9284
v_bfe_u32 v11, v0, 3, 1
v_lshl_add_u32 v3, v9, 2, v11
s_lshl_b32 s55, s2, 4
v_add_u32 v3, s55, v3
v_mul_u32_u24 v3, 1152, v3
v_lshl_add_u32 v4, v9, 1, v11
v_add_u32 v4, s74, v4
v_mul_u32_u24 v4, 1152, v4
v_and_b32 v11, 7, v0
v_lshlrev_b32 v11, 4, v11
s_lshl_b32 s55, s3, 7
v_add_u32 v11, s55, v11
v_add_u32 v3, v3, v11
v_add_u32 v4, v4, v11
s_lshl_b32 s55, s75, 1
v_mov_b32 v76, 1073741824
s_sub_i32 s55, s55, 4
v_cmp_gt_i32 vcc, s55, v9
v_add_u32 v94, 9216, v4
s_nop 0
v_cndmask_b32 v94, v76, v94, vcc
s_sub_i32 s55, s55, 4
v_cmp_gt_i32 vcc, s55, v9
v_add_u32 v75, 18432, v4
s_nop 0
v_cndmask_b32 v75, v76, v75, vcc
v_lshrrev_b32 v76, 1, v9
v_mul_u32_u24 v76, 2304, v76
v_and_b32 v77, 7, v0
v_lshl_add_u32 v76, v77, 5, v76
v_and_b32 v77, 1, v9
v_lshl_add_u32 v76, v77, 4, v76
s_mul_i32 s67, s2, 6144
s_lshl_b32 s55, s3, 8
s_add_u32 s67, s67, s55
s_add_u32 s67, s67, 1536
v_bfe_u32 v77, v0, 3, 1
v_lshlrev_b32 v77, 7, v77
v_lshl_add_u32 v77, v9, 3, v77
ds_read_b64 v[68:69], v77 offset:8704
ds_read_b64 v[70:71], v77 offset:8736
ds_read_b64 v[72:73], v77 offset:8768
v_lshrrev_b32 v10, 3, v0
v_lshlrev_b32 v10, 4, v10
s_and_b32 s55, s69, s65
v_mov_b32 v74, s55
s_lshl_b32 s54, s52, 7
v_lshl_add_u32 v124, v0, 2, s54
s_setprio 3
buffer_load_dwordx4 v[40:43], v4, s[24:27], 0 offen nt
buffer_load_dwordx4 v[44:47], v94, s[24:27], 0 offen nt
buffer_load_dwordx4 v[48:51], v75, s[24:27], 0 offen nt
buffer_load_dwordx4 v[52:55], v3, s[20:23], 0 offen nt
buffer_load_dwordx4 v[56:59], v3, s[20:23], 0 offen offset:2304 nt
buffer_load_dword v125, v124, s[4:7], 0 offen
s_setprio 0
v_and_b32 v3, 15, v0
s_lshl_b32 s55, s48, 4
v_add_u32 v116, s55, v3
v_mul_u32_u24 v3, 6144, v116
s_mul_i32 s56, s49, 80
v_lshl_add_u32 v4, v9, 4, v3
s_mul_i32 s42, s2, 6144
v_lshrrev_b32 v2, 2, v0
v_mul_u32_u24 v2, 80, v2
v_and_b32 v105, 3, v0
v_lshl_add_u32 v2, v105, 4, v2
v_mul_u32_u24 v105, 80, v0
s_mov_b32 s0, 0x01010101
s_mov_b32 s1, 0x01010101
v_lshl_add_u32 v118, v0, 4, s49
v_cmp_gt_u32 vcc, 18, v118
v_lshlrev_b32 v118, 10, v118
s_lshr_b32 s54, s48, 1
s_lshl_b32 s54, s54, 7
s_and_b32 s55, s48, 1
s_lshl2_add_u32 s54, s55, s54
s_add_u32 s59, s54, 1900544
s_mov_b64 s[60:61], vcc
s_getreg_b32 s68, hwreg(HW_REG_XCC_ID)
s_lshl_b32 s68, s68, 16
v_and_b32 v106, 15, v0
v_lshlrev_b32 v107, 2, v106
v_lshlrev_b32 v106, 3, v106
v_lshrrev_b32 v104, 5, v0
v_lshlrev_b32 v104, 5, v104
L_mlwait:
s_sleep 4
ds_read_b64 v[110:111], v106 offset:8960
s_add_u32 s64, s64, 1
s_cmp_gt_u32 s64, 1600000
s_waitcnt lgkmcnt(0)
v_cmp_eq_u32 vcc, -1, v111
v_max_f32_dpp v108, v110, v110 quad_perm:[1,0,3,2] row_mask:0xf bank_mask:0xf
s_cbranch_scc1 L_mlgot
s_cbranch_vccnz L_mlwait
L_mlgot:
s_setprio 3
v_max_f32_dpp v108, v108, v108 quad_perm:[2,3,0,1] row_mask:0xf bank_mask:0xf
s_nop 1
v_max_f32_dpp v108, v108, v108 row_half_mirror row_mask:0xf bank_mask:0xf
v_sub_f32 v110, v110, v108
v_mul_f32 v110, s63, v110
v_exp_f32 v110, v110
s_nop 0
ds_write_b32 v107, v110 offset:9216
v_mul_f32 v109, v111, v110
ds_read_b128 v[80:83], v104 offset:9216
ds_read_b128 v[84:87], v104 offset:9232
v_add_f32_dpp v109, v109, v109 quad_perm:[1,0,3,2] row_mask:0xf bank_mask:0xf
s_nop 1
v_add_f32_dpp v109, v109, v109 quad_perm:[2,3,0,1] row_mask:0xf bank_mask:0xf
s_nop 1
v_add_f32_dpp v109, v109, v109 row_half_mirror row_mask:0xf bank_mask:0xf
s_nop 1
v_mov_b32 v110, s68
v_bfi_b32 v108, s65, v74, v108
v_bfi_b32 v109, s65, v74, v109
v_bfi_b32 v110, s65, v74, v110
v_bfi_b32 v111, s65, v74, v111
s_mov_b32 s54, 0
s_add_u32 s57, s64, 40
s_barrier
ds_read_b128 v[128:131], v1 offset:0
ds_read_b128 v[132:135], v1 offset:1024
ds_read_b128 v[136:139], v1 offset:2048
ds_read_b128 v[140:143], v1 offset:3072
ds_read_b128 v[144:147], v1 offset:4096
ds_read_b128 v[148:151], v1 offset:5120
ds_read_b128 v[152:155], v1 offset:6144
ds_read_b128 v[156:159], v1 offset:7168
s_mov_b64 exec, 0xffff
buffer_store_dwordx4 v[108:111], v105, s[32:35], s42 offen offset:64
s_mov_b64 exec, -1
s_waitcnt lgkmcnt(7)
v_pk_mul_f32 v[128:129], v[128:129], v[80:81] op_sel:[0,0] op_sel_hi:[1,0]
v_pk_mul_f32 v[130:131], v[130:131], v[80:81] op_sel:[0,0] op_sel_hi:[1,0]
s_waitcnt lgkmcnt(6)
v_pk_fma_f32 v[128:129], v[132:133], v[80:81], v[128:129] op_sel:[0,1,0] op_sel_hi:[1,1,1]
v_pk_fma_f32 v[130:131], v[134:135], v[80:81], v[130:131] op_sel:[0,1,0] op_sel_hi:[1,1,1]
s_waitcnt lgkmcnt(5)
v_pk_fma_f32 v[128:129], v[136:137], v[82:83], v[128:129] op_sel:[0,0,0] op_sel_hi:[1,0,1]
v_pk_fma_f32 v[130:131], v[138:139], v[82:83], v[130:131] op_sel:[0,0,0] op_sel_hi:[1,0,1]
s_waitcnt lgkmcnt(4)
v_pk_fma_f32 v[128:129], v[140:141], v[82:83], v[128:129] op_sel:[0,1,0] op_sel_hi:[1,1,1]
v_pk_fma_f32 v[130:131], v[142:143], v[82:83], v[130:131] op_sel:[0,1,0] op_sel_hi:[1,1,1]
s_waitcnt lgkmcnt(3)
v_pk_fma_f32 v[128:129], v[144:145], v[84:85], v[128:129] op_sel:[0,0,0] op_sel_hi:[1,0,1]
v_pk_fma_f32 v[130:131], v[146:147], v[84:85], v[130:131] op_sel:[0,0,0] op_sel_hi:[1,0,1]
s_waitcnt lgkmcnt(2)
v_pk_fma_f32 v[128:129], v[148:149], v[84:85], v[128:129] op_sel:[0,1,0] op_sel_hi:[1,1,1]
v_pk_fma_f32 v[130:131], v[150:151], v[84:85], v[130:131] op_sel:[0,1,0] op_sel_hi:[1,1,1]
s_waitcnt lgkmcnt(1)
v_pk_fma_f32 v[128:129], v[152:153], v[86:87], v[128:129] op_sel:[0,0,0] op_sel_hi:[1,0,1]
v_pk_fma_f32 v[130:131], v[154:155], v[86:87], v[130:131] op_sel:[0,0,0] op_sel_hi:[1,0,1]
s_waitcnt lgkmcnt(0)
v_pk_fma_f32 v[128:129], v[156:157], v[86:87], v[128:129] op_sel:[0,1,0] op_sel_hi:[1,1,1]
v_pk_fma_f32 v[130:131], v[158:159], v[86:87], v[130:131] op_sel:[0,1,0] op_sel_hi:[1,1,1]
v_bfi_b32 v128, s65, v74, v128
v_bfi_b32 v129, s65, v74, v129
v_bfi_b32 v130, s65, v74, v130
v_bfi_b32 v131, s65, v74, v131
buffer_store_dwordx4 v[128:131], v2, s[32:35], s42 offen
buffer_load_dwordx4 v[60:63], v4, s[32:35], s56 offen sc1
buffer_load_dwordx4 v[64:67], v3, s[32:35], s56 offen offset:64 sc1
s_barrier
s_waitcnt vmcnt(4)
v_and_b32 v12, v68, v5
v_and_b32 v13, v68, v6
v_and_b32 v14, v68, v7
v_and_b32 v15, v68, v8
s_nop 1
v_mfma_f32_16x16x32_bf16 v[24:27], v[12:15], v[40:43], 0
v_and_b32 v16, v69, v5
v_and_b32 v17, v69, v6
v_and_b32 v18, v69, v7
v_and_b32 v19, v69, v8
s_nop 1
v_mfma_f32_16x16x32_bf16 v[28:31], v[16:19], v[40:43], 0
v_and_b32 v12, v70, v5
v_and_b32 v13, v70, v6
v_and_b32 v14, v70, v7
v_and_b32 v15, v70, v8
s_nop 1
v_mfma_f32_16x16x32_bf16 v[24:27], v[12:15], v[44:47], v[24:27]
v_and_b32 v16, v71, v5
v_and_b32 v17, v71, v6
v_and_b32 v18, v71, v7
v_and_b32 v19, v71, v8
s_nop 1
v_mfma_f32_16x16x32_bf16 v[28:31], v[16:19], v[44:47], v[28:31]
v_and_b32 v12, v72, v5
v_and_b32 v13, v72, v6
v_and_b32 v14, v72, v7
v_and_b32 v15, v72, v8
s_nop 1
v_mfma_f32_16x16x32_bf16 v[24:27], v[12:15], v[48:51], v[24:27]
v_and_b32 v16, v73, v5
v_and_b32 v17, v73, v6
v_and_b32 v18, v73, v7
v_and_b32 v19, v73, v8
s_nop 1
v_mfma_f32_16x16x32_bf16 v[28:31], v[16:19], v[48:51], v[28:31]
s_branch L_pollo1
L_otmo:
s_cmp_lg_u32 s54, 0
s_cbranch_scc1 L_goto
s_cmp_lg_u32 s37, 0
s_cbranch_scc1 L_spo
s_add_u32 s36, s36, s40
s_sub_u32 s36, s36, 1572864
s_mov_b32 s37, 1
s_mov_b64 exec, s[38:39]
s_setprio 3
buffer_store_dwordx4 v[96:99], v100, s[32:35], s36 offen sc1
s_setprio 0
s_mov_b64 exec, -1
L_spo:
s_setprio 3
s_mul_i32 s55, s2, 1280
s_add_u32 s55, s55, s40
s_add_u32 s55, s55, 262144
buffer_store_dwordx4 v[128:131], v2, s[32:35], s55 offen sc1
s_mov_b64 exec, 0xffff
buffer_store_dwordx4 v[108:111], v105, s[32:35], s55 offen offset:64 sc1
s_mov_b64 exec, -1
s_mov_b32 s54, 1
v_mul_u32_u24 v116, 1280, v116
v_lshl_add_u32 v117, v9, 4, v116
s_add_u32 s66, s56, s40
s_add_u32 s66, s66, 262144
s_add_u32 s57, s64, 100000
s_branch L_oswap
L_oretry:
s_cbranch_scc1 L_otmo
s_cmp_eq_u32 s54, 0
s_cbranch_scc1 L_pollo
L_oswap:
v_swap_b32 v3, v116
v_swap_b32 v4, v117
s_mov_b32 s55, s56
s_mov_b32 s56, s66
s_mov_b32 s66, s55
L_pollo:
buffer_load_dwordx4 v[60:63], v4, s[32:35], s56 offen sc1
buffer_load_dwordx4 v[64:67], v3, s[32:35], s56 offen offset:64 sc1
L_pollo1:
s_add_u32 s64, s64, 1
s_cmp_gt_u32 s64, s57
s_waitcnt vmcnt(0)
v_xor_b32 v64, v74, v64
v_xor_b32 v65, v74, v65
v_xor_b32 v66, v74, v66
v_xor_b32 v67, v74, v67
v_xor_b32 v60, v74, v60
v_xor_b32 v61, v74, v61
v_xor_b32 v62, v74, v62
v_xor_b32 v63, v74, v63
v_or3_b32 v77, v64, v65, v66
v_or3_b32 v77, v77, v67, v60
v_or3_b32 v77, v77, v61, v62
v_or_b32 v77, v77, v63
v_and_b32 v77, s65, v77
v_cmp_ne_u32 vcc, 0, v77
v_max_f32_dpp v77, v64, v64 quad_perm:[1,0,3,2] row_mask:0xf bank_mask:0xf
s_cbranch_vccnz L_oretry
v_cmp_ne_u32 vcc, s68, v66
s_cbranch_vccz L_goto
s_cmp_lg_u32 s54, 0
s_cbranch_scc1 L_goto
s_mul_i32 s55, s2, 1280
s_add_u32 s55, s55, s40
s_add_u32 s55, s55, 262144
buffer_store_dwordx4 v[128:131], v2, s[32:35], s55 offen sc1
s_mov_b64 exec, 0xffff
buffer_store_dwordx4 v[108:111], v105, s[32:35], s55 offen offset:64 sc1
s_mov_b64 exec, -1
s_mov_b32 s54, 1
L_goto:
v_max_f32_dpp v77, v77, v77 quad_perm:[2,3,0,1] row_mask:0xf bank_mask:0xf
s_nop 1
v_max_f32_dpp v77, v77, v77 row_half_mirror row_mask:0xf bank_mask:0xf
v_sub_f32 v64, v64, v77
v_mul_f32 v64, s63, v64
v_exp_f32 v64, v64
s_nop 0
v_mul_f32 v65, v65, v64
v_mul_f32 v60, v60, v64
v_mul_f32 v61, v61, v64
v_mul_f32 v62, v62, v64
v_mul_f32 v63, v63, v64
v_add_f32_dpp v65, v65, v65 quad_perm:[1,0,3,2] row_mask:0xf bank_mask:0xf
v_add_f32_dpp v60, v60, v60 quad_perm:[1,0,3,2] row_mask:0xf bank_mask:0xf
v_add_f32_dpp v61, v61, v61 quad_perm:[1,0,3,2] row_mask:0xf bank_mask:0xf
v_add_f32_dpp v62, v62, v62 quad_perm:[1,0,3,2] row_mask:0xf bank_mask:0xf
v_add_f32_dpp v63, v63, v63 quad_perm:[1,0,3,2] row_mask:0xf bank_mask:0xf
v_add_f32_dpp v65, v65, v65 quad_perm:[2,3,0,1] row_mask:0xf bank_mask:0xf
v_add_f32_dpp v60, v60, v60 quad_perm:[2,3,0,1] row_mask:0xf bank_mask:0xf
v_add_f32_dpp v61, v61, v61 quad_perm:[2,3,0,1] row_mask:0xf bank_mask:0xf
v_add_f32_dpp v62, v62, v62 quad_perm:[2,3,0,1] row_mask:0xf bank_mask:0xf
v_add_f32_dpp v63, v63, v63 quad_perm:[2,3,0,1] row_mask:0xf bank_mask:0xf
v_add_f32_dpp v65, v65, v65 row_half_mirror row_mask:0xf bank_mask:0xf
v_add_f32_dpp v60, v60, v60 row_half_mirror row_mask:0xf bank_mask:0xf
v_add_f32_dpp v61, v61, v61 row_half_mirror row_mask:0xf bank_mask:0xf
v_add_f32_dpp v62, v62, v62 row_half_mirror row_mask:0xf bank_mask:0xf
v_add_f32_dpp v63, v63, v63 row_half_mirror row_mask:0xf bank_mask:0xf
v_rcp_f32 v65, v65
s_mov_b64 exec, s[0:1]
v_mul_f32 v60, v60, v65
v_mul_f32 v61, v61, v65
v_mul_f32 v62, v62, v65
v_mul_f32 v63, v63, v65
v_cvt_pk_bf16_f32 v60, v60, v60
v_cvt_pk_bf16_f32 v61, v61, v61
v_cvt_pk_bf16_f32 v62, v62, v62
v_cvt_pk_bf16_f32 v63, v63, v63
ds_write_b128 v10, v[60:63] offset:9088
s_mov_b64 exec, -1
s_waitcnt lgkmcnt(0)
s_barrier
ds_read_b128 v[60:63], v10 offset:9088
s_waitcnt lgkmcnt(0)
s_branch L_tail
.p2align 6
.type L_tab,@object
.size L_tab, 1024
L_tab:
.long 0x16dff00, 0x16dff02, 0x1681f45, 0x16dff47, 0x16dff49, 0x16dff8e, 0x16dff90, 0x16be003
.long 0x16dff01, 0x1681f03, 0x16dff46, 0x16dff48, 0x16dff8d, 0x16dff8f, 0x16dff91, 0x16be045
.long 0x2dff04, 0x2dff06, 0x2dff40, 0x2dff42, 0x2dff44, 0x2dff89, 0x281f8b, 0x2be043
.long 0x2dff05, 0x2dff07, 0x2dff41, 0x281f43, 0x2dff88, 0x2dff8a, 0x2dff8c, 0x2be08b
.long 0x52dff08, 0x52dff0a, 0x5281f54, 0x52dff56, 0x52dff58, 0x52dff9d, 0x52dff9f, 0x52be00b
.long 0x52dff09, 0x5281f0b, 0x52dff55, 0x52dff57, 0x52dff9c, 0x52dff9e, 0x52dffa0, 0x52be054
.long 0x2adff0c, 0x2adff0e, 0x2adff4a, 0x2adff4c, 0x2adff4e, 0x2a81f93, 0x2adff95, 0x2abe04b
.long 0x2adff0d, 0x2adff0f, 0x2a81f4b, 0x2adff4d, 0x2adff92, 0x2adff94, 0x2adff96, 0x2abe093
.long 0x76dff10, 0x76dff12, 0x7681f5d, 0x76dff5f, 0x76dff61, 0x76dffa6, 0x76dffa8, 0x76be013
.long 0x76dff11, 0x7681f13, 0x76dff5e, 0x76dff60, 0x76dffa5, 0x76dffa7, 0x76dffa9, 0x76be05d
.long 0x3edff14, 0x3edff16, 0x3edff4f, 0x3edff51, 0x3e81f53, 0x3edff98, 0x3edff9a, 0x3ebe053
.long 0x3edff15, 0x3edff17, 0x3edff50, 0x3edff52, 0x3edff97, 0x3edff99, 0x3e81f9b, 0x3ebe09b
.long 0x9adff18, 0x9adff1a, 0x9a81f66, 0x9adff68, 0x9adff6a, 0x9adffaf, 0x9adffb1, 0x9abe01b
.long 0x9adff19, 0x9a81f1b, 0x9adff67, 0x9adff69, 0x9adffae, 0x9adffb0, 0x9adffb2, 0x9abe066
.long 0xaedff1c, 0xaedff1e, 0xae81f6b, 0xaedff6d, 0xaedff6f, 0xaedffb4, 0xaedffb6, 0xaebe06b
.long 0xaedff1d, 0xaedff1f, 0xaedff6c, 0xaedff6e, 0xae81fb3, 0xaedffb5, 0xaedffb7, 0xaebe0b3
.long 0x665ff20, 0x665ff22, 0x6601f59, 0x6601f5b, 0x665ffa1, 0x6601fa3, 0x663e023, 0x663e0a3
.long 0x665ff21, 0x6601f23, 0x665ff5a, 0x665ff5c, 0x665ffa2, 0x665ffa4, 0x663e05b, 0x663e059
.long 0x8a5ff24, 0x8a5ff26, 0x8a01f62, 0x8a01f64, 0x8a5ffaa, 0x8a5ffac, 0x8a3e063, 0x8a3e062
.long 0x8a5ff25, 0x8a5ff27, 0x8a01f63, 0x8a5ff65, 0x8a01fab, 0x8a5ffad, 0x8a3e0ab, 0x8a3e064
.long 0xc25ff28, 0xc25ff2a, 0xc201f70, 0xc25ff72, 0xc25ffb8, 0xc25ffba, 0xc23e02b, 0xc23e0bb
.long 0xc25ff29, 0xc201f2b, 0xc25ff71, 0xc201f73, 0xc25ffb9, 0xc201fbb, 0xc23e073, 0xc23e070
.long 0xd25ff2c, 0xd25ff2e, 0xd201f74, 0xd201f76, 0xd25ffbc, 0xd25ffbe, 0xd23e074, 0xd23e076
.long 0xd25ff2d, 0xd25ff2f, 0xd201f75, 0xd201f77, 0xd25ffbd, 0xd25ffbf, 0xd23e075, 0xd23e077
.long 0xe25ff30, 0xe25ff32, 0xe201f78, 0xe25ff7a, 0xe25ffc0, 0xe25ffc2, 0xe23e033, 0xe23e0c3
.long 0xe25ff31, 0xe201f33, 0xe25ff79, 0xe201f7b, 0xe25ffc1, 0xe201fc3, 0xe23e07b, 0xe23e078
.long 0xf25ff34, 0xf25ff36, 0xf201f7c, 0xf201f7e, 0xf25ffc4, 0xf25ffc6, 0xf23e07c, 0xf23e07e
.long 0xf25ff35, 0xf25ff37, 0xf201f7d, 0xf201f7f, 0xf25ffc5, 0xf25ffc7, 0xf23e07d, 0xf23e07f
.long 0x1025ff38, 0x1025ff3a, 0x10201f80, 0x1025ff82, 0x1025ffc8, 0x1025ffca, 0x1023e03b, 0x1023e0cb
.long 0x1025ff39, 0x10201f3b, 0x1025ff81, 0x10201f83, 0x1025ffc9, 0x10201fcb, 0x1023e083, 0x1023e080
.long 0x1125ff3c, 0x1125ff3e, 0x11201f84, 0x11201f86, 0x1125ffcc, 0x1125ffce, 0x1123e084, 0x1123e086
.long 0x1125ff3d, 0x1125ff3f, 0x11201f85, 0x11201f87, 0x1125ffcd, 0x1125ffcf, 0x1123e085, 0x1123e087
.section .rodata,"a"
.p2align 6
.amdhsa_kernel parallel_sum__sliding_block_cached__glu_gated_swiglu__decode_kernel
  .amdhsa_next_free_vgpr 168
  .amdhsa_next_free_sgpr 102
  .amdhsa_accum_offset 168
  .amdhsa_group_segment_fixed_size 0
  .amdhsa_kernarg_size 96
  .amdhsa_user_sgpr_count 2
  .amdhsa_user_sgpr_kernarg_segment_ptr 1
  .amdhsa_system_sgpr_workgroup_id_x 1
.end_amdhsa_kernel
```
